```python
import torch

def _softmax(x, axis=-1):
    return torch.softmax(x, dim=axis)
def _gelu(x):
    return torch.nn.functional.gelu(x, approximate="tanh")
def _silu(x):
    return torch.nn.functional.silu(x)
def _sigmoid(x):
    return torch.sigmoid(x)
def _layernorm(x, axis=-1, eps=1e-5):
    m = x.mean(dim=axis, keepdim=True)
    v = x.var(dim=axis, keepdim=True, unbiased=False)
    return (x - m) / torch.sqrt(v + eps)
def _scatter_add(tgt, idx, src, axis=0):
    return tgt.clone().index_add_(axis, idx, src)
def _segment_sum(src, seg, n):
    out = torch.zeros((n,) + src.shape[1:], dtype=src.dtype)
    return out.index_add_(0, seg, src)
def _pad(x, pw):
    flat = tuple(v for pair in reversed(pw) for v in pair)
    return torch.nn.functional.pad(x, flat)

kernel_name = 'concat_heads__linear_kernel_hedgehog__sliding_block__prompt'

def setup_inputs():

    _w = (lambda a: (lambda t: t.to(torch.bfloat16) if t.is_floating_point() else t)(torch.as_tensor(a)))
    def _A_setup():
        B, S, D, H = 1, 2048, 512, 32
        Dh = D // H
        return {
            "x": _w((lambda *s: torch.randn(*s, dtype=torch.bfloat16) * 0.1)(B, S, D)),
            "wqkv": _w((lambda *s: torch.randn(*s, dtype=torch.bfloat16) * 1.6)(D, 3 * D)),
            "w_phi": _w((lambda *s: torch.randn(*s, dtype=torch.bfloat16) * 1.6)(H, Dh, Dh) * (Dh ** -0.5)),
            "wo": _w((lambda *s: torch.randn(*s, dtype=torch.bfloat16) * 3.2)(D, D)),
        }
    _A_in = _A_setup()

    def _B_setup():
        B, S, D = 1, 2048, 512
        return {
            "x": _w((lambda *s: torch.randn(*s, dtype=torch.bfloat16) * 0.2)(B, S, D)),
            "wqkv": _w((lambda *s: torch.randn(*s, dtype=torch.bfloat16) * 0.4)(D, 3 * D)),
            "wo": _w((lambda *s: torch.randn(*s, dtype=torch.bfloat16) * 0.4)(D, D)),
        }
    _B_in = _B_setup()

    return {
        "A_x": _A_in["x"],
        "A_wqkv": _A_in["wqkv"],
        "A_w_phi": _A_in["w_phi"],
        "A_wo": _A_in["wo"],
        "B_x": _B_in["x"],
        "B_wqkv": _B_in["wqkv"],
        "B_wo": _B_in["wo"],
    }

def reference(A_x, A_wqkv, A_w_phi, A_wo, B_x, B_wqkv, B_wo):
    def _A_ref(x, wqkv, w_phi, wo):
        B, S, D = x.shape
        H = 32; Dh = D // H
        qkv = (lambda x, *d: x.permute(*d))((x @ wqkv).reshape(B, S, 3, H, Dh), 2, 0, 3, 1, 4)
        q, k, v = qkv[0], qkv[1], qkv[2]
        pq = torch.einsum("bhsd,hdf->bhsf", q, w_phi)
        pk = torch.einsum("bhsd,hdf->bhsf", k, w_phi)
        phi_q = torch.concatenate([_softmax(pq, axis=-1), _softmax(-pq, axis=-1)], axis=-1)
        phi_k = torch.concatenate([_softmax(pk, axis=-1), _softmax(-pk, axis=-1)], axis=-1)
        kv = torch.einsum("bhsf,bhsd->bhfd", phi_k, v)
        z  = torch.einsum("bhsf->bhf", phi_k)
        num = torch.einsum("bhqf,bhfd->bhqd", phi_q, kv)
        den = torch.einsum("bhqf,bhf->bhq", phi_q, z)[..., None] + 1e-6
        o = num / den
        return (lambda x, *d: x.permute(*d))(o, 0, 2, 1, 3).reshape(B, S, D) @ wo

    def _B_ref(x, wqkv, wo):
        B, S, D = x.shape
        H = 32; Dh = D // H; W = 256
        qkv = (lambda x, *d: x.permute(*d))((x @ wqkv).reshape(B, S, 3, H, Dh), 2, 0, 3, 1, 4)
        q, k, v = qkv[0], qkv[1], qkv[2]
        scores = torch.einsum("bhqd,bhkd->bhqk", q, k) * (Dh ** -0.5)
        idx = torch.arange(S)
        mask = (idx[:, None] - idx[None, :] >= 0) & (idx[:, None] - idx[None, :] < W)
        scores = torch.where(mask[None, None], scores, -1e9)
        p = _softmax(scores, axis=-1)
        o = torch.einsum("bhqk,bhkd->bhqd", p, v)
        return (lambda x, *d: x.permute(*d))(o, 0, 2, 1, 3).reshape(B, S, D) @ wo

    a = _A_ref(A_x, A_wqkv, A_w_phi, A_wo)
    b = _B_ref(B_x, B_wqkv, B_wo)
    return torch.concatenate([a, b], axis=-1)
```

```asm
; @launch grid=(256,1,1) block=(512,1,1) lds=163840
.amdgcn_target "amdgcn-amd-amdhsa--gfx950"
.text
.globl concat_heads__linear_kernel_hedgehog__sliding_block__prompt_kernel
.p2align 12
.type concat_heads__linear_kernel_hedgehog__sliding_block__prompt_kernel,@function
concat_heads__linear_kernel_hedgehog__sliding_block__prompt_kernel:
    s_load_dwordx16 s[4:19], s[0:1], 0
    s_load_dwordx4 s[20:23], s[0:1], 64
    s_cmp_ge_u32 s2, 256
    s_cbranch_scc1 L_end
    s_getreg_b32 s99, hwreg(HW_REG_XCC_ID, 0, 3)
L_restart:
    s_getpc_b64 s[24:25]
L_pc0:
    s_and_b32 s3, s2, 0xf8
    s_lshl_b32 s3, s3, 4
    v_lshl_add_u32 v13, v0, 12, s3
    v_min_u32 v13, L_cold-L_pc0-4, v13
    v_cmp_gt_u32 vcc, 7, v0
    s_and_b64 exec, exec, vcc
    s_cbranch_scc0 L_pc1
    global_load_dword v255, v13, s[24:25]
L_pc1:
    s_mov_b64 exec, -1
    v_lshrrev_b32 v2, 6, v0
    v_and_b32 v1, 63, v0
    s_lshl_b32 s36, s99, 2
    s_lshr_b32 s36, 0x76325410, s36
    s_and_b32 s36, s36, 7
    s_bfe_u32 s37, s2, 0x50003
    v_readfirstlane_b32 s41, v2
    s_and_b32 s38, s37, 1
    s_and_b32 s39, s36, 3
    s_lshl_b32 s39, s39, 2
    s_bfe_u32 s42, s37, 0x20001
    s_add_u32 s39, s39, s42
    s_lshl_b32 s35, s38, 2
    s_xor_b32 s35, s35, s36
    s_and_b32 s35, s35, 4
    s_lshr_b32 s42, s37, 3
    s_add_u32 s35, s35, s42
    s_lshl_b32 s40, s35, 1
    s_add_u32 s40, s40, s38
    v_lshlrev_b32 v8, 4, v1
    v_and_b32 v10, 31, v1
    v_lshrrev_b32 v11, 5, v1
    s_cmp_lt_u32 s41, 4
    s_cbranch_scc1 L_cpre
    s_mov_b32 s46, 0x200000
    s_mov_b32 s47, 0x20000
    s_mov_b32 s50, 0x180000
    s_mov_b32 s51, 0x20000
    s_sub_u32 s43, s41, 4
    v_lshrrev_b32 v3, 3, v1
    v_and_b32 v4, 7, v1
    v_lshrrev_b32 v5, 4, v1
    v_xor_b32 v6, v4, v5
    v_lshlrev_b32 v6, 4, v6
    v_lshl_add_u32 v6, v3, 10, v6
    s_lshl_b32 s24, s39, 17
    s_lshl_b32 s25, s43, 15
    s_add_u32 s24, s24, s25
    v_add_u32 v16, s24, v6
    v_xor_b32 v17, 64, v16
    v_add_u32 v17, 8192, v17
    v_add_u32 v18, 16384, v16
    v_add_u32 v19, 16384, v17
    v_and_b32 v5, 1, v5
    v_lshlrev_b32 v5, 2, v5
    v_xor_b32 v4, v4, v5
    v_mul_u32_u24 v3, 3072, v3
    v_lshl_add_u32 v3, v4, 4, v3
    s_mul_i32 s24, s43, 49152
    s_lshl_b32 s25, s35, 7
    s_add_u32 s24, s24, s25
    v_add_u32 v20, s24, v3
    v_xor_b32 v21, 32, v20
    v_add_u32 v21, 24576, v21
    s_lshl_b32 s30, s43, 12
    s_lshl_b32 s31, s43, 11
    s_add_u32 s26, s39, s35
    s_and_b32 s26, s26, 1
    s_lshl_b32 s26, s26, 9
    s_lshl1_add_u32 s27, s36, s38
    s_lshl_b32 s27, s27, 1
    s_lshr_b32 s27, 0x14141414, s27
    s_and_b32 s27, s27, 3
    s_lshl_b32 s27, s27, 7
    s_xor_b32 s26, s26, s27
    s_cmp_eq_u32 s38, 0
    s_waitcnt lgkmcnt(0)
    s_cselect_b32 s44, s12, s4
    s_cselect_b32 s45, s13, s5
    s_cselect_b32 s48, s14, s6
    s_cselect_b32 s49, s15, s7
    s_xor_b32 s32, s26, 0
    s_mul_i32 s33, s32, 1536
    s_add_u32 m0, s31, 15360
    s_nop 0
    buffer_load_dwordx4 v20, s[48:51], s33 offen offset:1024 lds
    s_add_u32 m0, s31, 16384
    s_nop 0
    buffer_load_dwordx4 v21, s[48:51], s33 offen offset:1024 lds
    s_add_u32 m0, s31, 22528
    s_nop 0
    buffer_load_dwordx4 v20, s[48:51], s33 offen offset:2048 lds
    s_add_u32 m0, s31, 23552
    s_nop 0
    buffer_load_dwordx4 v21, s[48:51], s33 offen offset:2048 lds
    s_xor_b32 s32, s26, 0
    s_mul_i32 s33, s32, 1536
    s_add_u32 m0, s30, 0
    s_nop 0
    buffer_load_dwordx4 v16, s[44:47], s32 offen lds
    s_add_u32 m0, s30, 1024
    s_nop 0
    buffer_load_dwordx4 v17, s[44:47], s32 offen lds
    s_add_u32 m0, s30, 2048
    s_nop 0
    buffer_load_dwordx4 v18, s[44:47], s32 offen lds
    s_add_u32 m0, s30, 3072
    s_nop 0
    buffer_load_dwordx4 v19, s[44:47], s32 offen lds
    s_xor_b32 s32, s26, 128
    s_mul_i32 s33, s32, 1536
    s_add_u32 m0, s30, 32768
    s_nop 0
    buffer_load_dwordx4 v16, s[44:47], s32 offen lds
    s_add_u32 m0, s30, 33792
    s_nop 0
    buffer_load_dwordx4 v17, s[44:47], s32 offen lds
    s_mov_b32 s52, s22
    s_mov_b32 s53, s23
    s_mov_b32 s54, 0x1800000
    s_mov_b32 s55, 0x20000
    s_mov_b32 s56, s20
    s_mov_b32 s57, s21
    s_mov_b32 s58, 0x100
    s_mov_b32 s59, 0x20000
    s_branch L_load
L_cpre:
    s_lshr_b32 s42, s41, 1
    s_and_b32 s43, s41, 1
    v_mov_b64 v[16:17], 0
    v_mov_b64 v[18:19], 0
    v_mov_b64 v[20:21], 0
    v_mov_b64 v[22:23], 0
    s_lshl_b32 s24, s35, 1
    s_add_u32 s24, s24, s43
    s_lshl_b32 s34, s39, 18
    s_lshl_b32 s25, s42, 11
    s_lshl_b32 s32, s24, 14
    s_add_u32 s32, s32, s25
    s_add_u32 s32, s32, s34
    s_lshl_b32 s24, s24, 1
    s_add_u32 s24, s24, s42
    s_lshl_b32 s24, s24, 7
    s_add_u32 s34, s34, s24
    s_add_u32 s34, s34, 20971520
    s_waitcnt lgkmcnt(0)
    s_mov_b32 s52, s22
    s_mov_b32 s53, s23
    s_mov_b32 s54, 0x1800000
    s_mov_b32 s55, 0x20000
    s_mov_b32 s56, s20
    s_mov_b32 s57, s21
    s_mov_b32 s58, 0x100
    s_mov_b32 s59, 0x20000
    s_cmp_lg_u32 s41, 0
    s_cbranch_scc1 L_d1
    s_mov_b32 s44, s8
    s_mov_b32 s45, s9
    s_mov_b32 s46, 0x4000
    s_mov_b32 s47, 0x20000
    s_lshl_b32 s24, s35, 11
    s_mov_b32 m0, 161792
    s_nop 0
    buffer_load_dwordx4 v8, s[44:47], s24 offen offset:0 lds
    buffer_load_dwordx4 v8, s[44:47], s24 offen offset:1024 lds
    v_mov_b32 v12, 149376
    v_lshl_add_u32 v12, v1, 2, v12
    s_mov_b32 exec_hi, 0
    ds_write_b32 v12, v16
    s_mov_b64 exec, -1
L_d1:
    s_cmp_lg_u32 s41, 1
    s_cbranch_scc1 L_d2
    s_cmp_ge_u32 s2, 32
    s_cbranch_scc1 L_d2
    s_mul_i32 s24, s2, 2048
    s_add_u32 s24, s24, 17825792
    buffer_store_dwordx4 v[16:19], v8, s[52:55], s24 offen sc1
    buffer_store_dwordx4 v[16:19], v8, s[52:55], s24 offen offset:1024 sc1
    s_add_u32 s24, s24, 65536
    s_lshr_b32 s25, s2, 1
    s_lshl_b32 s25, s25, 18
    s_and_b32 s3, s2, 1
    s_lshl_b32 s3, s3, 13
    s_add_u32 s25, s25, s3
    s_add_u32 s25, s25, 20971520
    s_add_u32 s3, s25, 4096
    buffer_store_dwordx4 v[16:19], v8, s[52:55], s3 offen sc1
    buffer_store_dwordx4 v[16:19], v8, s[52:55], s3 offen offset:1024 sc1
    buffer_store_dwordx4 v[16:19], v8, s[52:55], s25 offen offset:0 sc1
    buffer_store_dwordx4 v[16:19], v8, s[52:55], s25 offen offset:1024 sc1
    buffer_store_dwordx4 v[16:19], v8, s[52:55], s25 offen offset:2048 sc1
    buffer_store_dwordx4 v[16:19], v8, s[52:55], s25 offen offset:3072 sc1
    s_mov_b64 exec, 0xff00
    v_mov_b32 v20, 1.0
    v_mov_b32 v21, 1.0
    v_mov_b32 v22, 1.0
    v_mov_b32 v23, 1.0
    s_mov_b64 exec, -1
    buffer_store_dwordx4 v[20:23], v8, s[52:55], s24 offen sc1
L_d2:
    s_cmp_lg_u32 s41, 2
    s_cbranch_scc1 L_d21
    s_sub_u32 s24, s2, 32
    s_cmp_ge_u32 s24, 32
    s_cbranch_scc1 L_d21
    s_and_b32 s24, s37, 2
    s_add_u32 s24, s24, s37
    s_add_u32 s24, s24, s24
    s_and_b32 s24, s24, 10
    s_lshl_b32 s24, s24, 11
    s_lshl_b32 s26, s36, 8
    s_add_u32 s26, s26, s24
    s_add_u32 s26, s26, 17989632
    s_buffer_load_dword s60, s[52:55], s26 glc
    s_buffer_load_dword s60, s[52:55], s26 offset:8192 glc
L_d21:
    s_cmp_lg_u32 s41, 3
    s_cbranch_scc1 L_d3
    s_cmp_lg_u32 s2, 0
    s_cbranch_scc1 L_d3
    s_mov_b32 s24, 17956864
    buffer_load_dword v250, v16, s[52:55], s24 offen sc1
L_d3:
    s_cmp_lt_u32 s36, 4
    s_cselect_b32 s44, s10, s16
    s_cselect_b32 s45, s11, s17
    s_mov_b32 s46, 0x80000
    s_mov_b32 s47, 0x20000
    s_mov_b32 s64, 0xffffffff
    s_mov_b32 s65, 0xfffffff0
    s_mov_b32 s66, 0xfffffffe
    s_mov_b32 s67, 0xffffffe0
    s_mov_b32 s68, 0xfffffffc
    s_mov_b32 s69, 0xffffffc0
    s_mov_b32 s70, 0xfffffff8
    s_mov_b32 s71, 0xffffff80
    s_mov_b32 s72, 0xffffff00
    s_mov_b32 s73, 0xfffff000
    s_mov_b32 s74, 0xfffffe00
    s_mov_b32 s75, 0xffffe000
    s_mov_b32 s76, 0xfffffc00
    s_mov_b32 s77, 0xffffc000
    s_mov_b32 s78, 0xfffff800
    s_mov_b32 s79, 0xffff8000
    s_mov_b32 s80, 0xffff0000
    s_mov_b32 s81, 0xfff00000
    s_mov_b32 s82, 0xfffe0000
    s_mov_b32 s83, 0xffe00000
    s_mov_b32 s84, 0xfffc0000
    s_mov_b32 s85, 0xffc00000
    s_mov_b32 s86, 0xfff80000
    s_mov_b32 s87, 0xff800000
    s_mov_b32 s88, 0xff000000
    s_mov_b32 s89, 0xf0000000
    s_mov_b32 s90, 0xfe000000
    s_mov_b32 s91, 0xe0000000
    s_mov_b32 s92, 0xfc000000
    s_mov_b32 s93, 0xc0000000
    s_mov_b32 s94, 0xf8000000
    s_mov_b32 s95, 0x80000000
    s_mov_b32 s62, 0x3fb8aa3b
    s_mov_b32 s63, 0x71800000
    s_mov_b32 s28, 0xffff
    s_mov_b32 s29, 0xffff
    v_mov_b32 v240, 0x3f803f80
    v_and_b32 v243, 11, v1
    v_cmp_eq_u32 vcc, 0, v243
    s_nop 1
    v_cndmask_b32 v240, 0, v240, vcc
    v_mov_b32 v241, v240
    v_mov_b32 v243, 0xffff
    v_mov_b64 v[216:217], v[240:241]
    v_mov_b64 v[218:219], v[240:241]
    v_mov_b64 v[220:221], v[240:241]
    v_mov_b64 v[222:223], v[240:241]
    v_mov_b64 v[224:225], v[240:241]
    v_mov_b64 v[226:227], v[240:241]
    v_mov_b64 v[228:229], v[240:241]
    v_mov_b64 v[230:231], v[240:241]
    v_cndmask_b32_e64 v232, 0, v243, s[64:65]
    v_cndmask_b32_e64 v233, 0, v243, s[68:69]
    v_cndmask_b32_e64 v234, 0, v243, s[72:73]
    v_cndmask_b32_e64 v235, 0, v243, s[76:77]
    v_cndmask_b32_e64 v236, 0, v243, s[80:81]
    v_cndmask_b32_e64 v237, 0, v243, s[84:85]
    v_cndmask_b32_e64 v238, 0, v243, s[88:89]
    v_cndmask_b32_e64 v239, 0, v243, s[92:93]
    v_cndmask_b32_e64 v232, v232, -1, s[66:67]
    v_cndmask_b32_e64 v233, v233, -1, s[70:71]
    v_cndmask_b32_e64 v234, v234, -1, s[74:75]
    v_cndmask_b32_e64 v235, v235, -1, s[78:79]
    v_cndmask_b32_e64 v236, v236, -1, s[82:83]
    v_cndmask_b32_e64 v237, v237, -1, s[86:87]
    v_cndmask_b32_e64 v238, v238, -1, s[90:91]
    v_cndmask_b32_e64 v239, v239, -1, s[94:95]
    s_and_b32 s21, s41, 3
    s_lshr_b32 s22, s41, 2
    s_lshl1_add_u32 s20, s22, s38
    s_lshl1_add_u32 s98, s21, s22
    s_lshl_b32 s98, s98, 12
    s_add_u32 s98, s98, 114688
    v_and_b32 v243, 17, v10
    v_cndmask_b32_e64 v242, v243, v10, s[28:29]
    v_and_b32 v243, 7, v242
    v_lshlrev_b32 v248, 2, v11
    v_xor_b32 v243, v243, v248
    v_lshl_add_u32 v242, v242, 3, v243
    v_lshl_add_u32 v242, v242, 4, s98
    v_lshrrev_b32 v248, 3, v1
    v_xor_b32 v248, v248, v1
    v_lshlrev_b32 v248, 4, v248
    s_lshl_b32 s24, s21, 10
    s_add_u32 s25, s24, 149504
    v_add_u32 v249, s25, v8
    s_mul_i32 s25, s22, 12288
    s_add_u32 s24, s24, s25
    s_add_u32 s25, s24, 65536
    v_add_u32 v245, s25, v8
    v_and_b32 v246, 15, v1
    v_lshlrev_b32 v246, 4, v246
    v_lshl_add_u32 v246, v11, 8, v246
    s_add_u32 s25, s24, 90112
    v_add_u32 v246, s25, v246
    v_lshrrev_b32 v247, 3, v1
    v_and_b32 v244, 7, v1
    v_bfe_u32 v243, v1, 4, 1
    v_lshlrev_b32 v243, 2, v243
    v_xor_b32 v244, v244, v243
    v_lshlrev_b32 v244, 4, v244
    v_lshl_add_u32 v247, v247, 10, v244
    v_mov_b32 v243, 1
    v_mov_b32 v244, 0
    v_mov_b64 v[52:53], 0
    v_mov_b64 v[54:55], 0
    s_lshl_b32 s4, s39, 2
    s_add_u32 s4, s4, s21
    s_lshr_b32 s23, s37, 2
    s_lshl_b32 s23, s23, 7
    v_add_u32 v247, s23, v247
    s_and_b32 s24, s37, 3
    s_lshl_b32 s24, s24, 4
    s_add_u32 s24, s24, s21
    s_lshl_b32 s5, s24, 10
    s_lshl_b32 s24, s40, 1
    s_add_u32 s24, s24, s22
    s_mul_i32 s6, s24, 2048
    s_add_u32 s6, s6, 17825792
    s_lshl_b32 s24, s21, 1
    s_add_u32 s24, s24, s22
    s_lshl_b32 s13, s24, 15
    s_add_u32 s13, s13, 4194304
    s_lshl_b32 s24, s24, 7
    s_add_u32 s12, s24, 20975616
    s_lshl4_add_u32 s24, s38, s35
    s_lshl_b32 s24, s24, 10
    s_lshl_b32 s25, s39, 18
    s_add_u32 s24, s24, s25
    s_add_u32 s7, s24, s13
    s_add_u32 s8, s12, s25
    s_lshl_b32 s24, s35, 15
    s_add_u32 s25, s25, s24
    s_and_b32 s24, s21, 2
    s_add_u32 s24, s24, s21
    s_add_u32 s24, s24, s24
    s_and_b32 s24, s24, 10
    s_lshl_b32 s24, s24, 11
    s_add_u32 s25, s25, s24
    s_and_b32 s24, s35, 1
    s_lshl_b32 s24, s24, 10
    s_add_u32 s25, s25, s24
    s_mul_i32 s24, s38, 2105344
    s_add_u32 s25, s25, s24
    s_add_u32 s15, s25, 8388608
    s_and_b32 s24, s39, 12
    s_xor_b32 s24, s24, 4
    s_and_b32 s25, s37, 3
    s_add_u32 s24, s24, s25
    s_lshr_b32 s22, s36, 2
    s_lshl_b32 s14, s24, 18
    s_add_u32 s12, s12, s14
    s_add_u32 s13, s13, s14
    s_mul_i32 s25, s22, 2105344
    s_add_u32 s13, s13, s25
    s_lshl_b32 s25, s22, 10
    s_add_u32 s12, s12, s25
    s_add_u32 s14, s14, s25
    s_lshl_b32 s25, s21, 16
    s_add_u32 s14, s14, s25
    s_add_u32 s14, s14, s23
    v_lshrrev_b32 v4, 4, v1
    v_bfe_u32 v12, v1, 1, 3
    v_xor_b32 v12, v12, v4
    v_and_b32 v13, 15, v1
    v_lshl_add_u32 v12, v13, 3, v12
    s_lshl_b32 s24, s42, 13
    v_lshl_add_u32 v2, v12, 4, s24
    v_xor_b32 v3, 64, v2
    v_bfe_u32 v12, v1, 2, 2
    v_lshl_add_u32 v12, v4, 3, v12
    v_lshlrev_b32 v12, 7, v12
    v_bfe_u32 v13, v1, 3, 1
    v_xor_b32 v13, s43, v13
    v_lshl_add_u32 v12, v13, 6, v12
    v_bfe_u32 v13, v1, 4, 1
    v_lshl_add_u32 v12, v13, 5, v12
    v_and_b32 v14, 3, v1
    v_lshl_add_u32 v6, v14, 3, v12
    v_bfrev_b32 v4, v14
    v_lshrrev_b32 v4, 27, v4
    v_add_u32 v4, v4, v12
    v_bfe_u32 v9, v1, 2, 2
    v_lshl_add_u32 v9, v11, 2, v9
    v_lshlrev_b32 v9, 5, v9
    v_lshl_add_u32 v9, v14, 3, v9
    s_lshl_b32 s24, s43, 10
    s_add_u32 s24, s24, 161792
    v_add_u32 v9, s24, v9
    v_mov_b32 v15, 149376
    s_and_b32 s24, s38, s42
    s_lshl_b32 s25, s24, 5
    v_xor_b32 v4, s25, v4
    v_xor_b32 v6, s25, v6
    s_lshl_b32 s25, s24, 9
    v_xor_b32 v9, s25, v9
    v_xor_b32 v14, 512, v9
    v_xor_b32 v5, 32, v4
    v_xor_b32 v7, 32, v6
    v_add_u32 v160, 0x10000, v2
    v_add_u32 v161, 0x10000, v3
    v_add_u32 v162, 0x10000, v4
    v_add_u32 v163, 0x10000, v5
    v_add_u32 v164, 0x10000, v6
    v_add_u32 v165, 0x10000, v7
    s_lshl_b32 s24, s39, 18
    s_lshl_b32 s25, s40, 8
    s_add_u32 s11, s25, s24
    s_add_u32 s11, s11, 20971520
    s_lshl_b32 s33, s40, 14
    s_add_u32 s33, s33, s24
    s_lshl_b32 s25, s43, 12
    s_add_u32 s33, s33, s25
    s_mul_i32 s25, s42, 2105344
    s_add_u32 s33, s33, s25
    s_mul_i32 s27, s41, 12288
    s_add_u32 s27, s27, 65536
    s_min_u32 s24, s39, 2
    s_lshl_b32 s24, s24, 18
    s_sub_u32 s9, s11, s24
    s_min_u32 s24, s24, 262144
    s_sub_u32 s10, s11, s24
    s_cmp_eq_u32 s38, 1
    s_cbranch_scc1 L_cpA
    v_and_b32 v12, 15, v1
    v_lshlrev_b32 v12, 4, v12
    v_lshl_add_u32 v12, v11, 8, v12
    v_lshl_add_u32 v52, v13, 12, v12
    s_lshl_b32 s25, s42, 11
    v_mul_u32_u24 v13, 12288, v13
    v_add_u32 v12, v12, v13
    s_add_u32 s24, s25, 98304
    v_add_u32 v53, s24, v12
    s_add_u32 s24, s25, 73728
    v_add_u32 v54, s24, v8
    s_add_u32 s30, s32, 4096
    s_add_u32 s31, s32, 2105344
    s_branch L_cpd
L_cpA:
    v_mov_b64 v[168:169], v[240:241]
    v_mov_b64 v[170:171], v[240:241]
    v_mov_b64 v[172:173], v[240:241]
    v_mov_b64 v[174:175], v[240:241]
    v_mov_b64 v[176:177], v[240:241]
    v_mov_b64 v[178:179], v[240:241]
    v_mov_b64 v[180:181], v[240:241]
    v_mov_b64 v[182:183], v[240:241]
    v_mov_b64 v[184:185], v[240:241]
    v_mov_b64 v[186:187], v[240:241]
    v_mov_b64 v[188:189], v[240:241]
    v_mov_b64 v[190:191], v[240:241]
    v_mov_b64 v[192:193], v[240:241]
    v_mov_b64 v[194:195], v[240:241]
    v_mov_b64 v[196:197], v[240:241]
    v_mov_b64 v[198:199], v[240:241]
    s_mul_i32 s30, s41, 8704
    s_add_u32 s30, s30, 114688
    v_and_b32 v12, 1, v1
    v_lshlrev_b32 v12, 4, v12
    v_mov_b32 v13, 0x3f80
    v_lshlrev_b32 v13, v12, v13
    v_lshlrev_b32 v12, 4, v11
    v_sub_u32 v12, v10, v12
    v_lshrrev_b32 v12, 1, v12
    v_cmp_eq_u32 vcc, 0, v12
    s_nop 1
    v_cndmask_b32 v200, 0, v13, vcc
    v_cmp_eq_u32 vcc, 1, v12
    s_nop 1
    v_cndmask_b32 v201, 0, v13, vcc
    v_cmp_eq_u32 vcc, 2, v12
    s_nop 1
    v_cndmask_b32 v202, 0, v13, vcc
    v_cmp_eq_u32 vcc, 3, v12
    s_nop 1
    v_cndmask_b32 v203, 0, v13, vcc
    v_cmp_eq_u32 vcc, 4, v12
    s_nop 1
    v_cndmask_b32 v204, 0, v13, vcc
    v_cmp_eq_u32 vcc, 5, v12
    s_nop 1
    v_cndmask_b32 v205, 0, v13, vcc
    v_cmp_eq_u32 vcc, 6, v12
    s_nop 1
    v_cndmask_b32 v206, 0, v13, vcc
    v_cmp_eq_u32 vcc, 7, v12
    s_nop 1
    v_cndmask_b32 v207, 0, v13, vcc
    v_lshlrev_b32 v54, 2, v10
    v_lshl_add_u32 v54, v11, 9, v54
    v_add_u32 v52, s30, v8
    s_xor_b32 s24, s41, 2
    s_mul_i32 s25, s24, 8704
    s_add_u32 s25, s25, 114688
    v_add_u32 v53, s25, v8
    v_and_b32 v12, 31, v1
    v_lshl_add_u32 v12, v12, 1, v11
    v_lshl_add_u32 v251, v12, 3, s30
    v_and_b32 v12, 15, v1
    v_lshl_add_u32 v12, v11, 4, v12
    v_lshl_add_u32 v55, v12, 4, s30
    s_lshl_b32 s24, s35, 2
    s_lshl_b32 s25, s43, 1
    s_add_u32 s24, s24, s25
    s_add_u32 s24, s24, s42
    s_xor_b32 s24, s24, 1
    s_mul_i32 s31, s24, 2048
    s_add_u32 s31, s31, 17825792
L_cpd:
    s_cmp_lg_u32 s41, 2
    s_cbranch_scc1 L_d8
    s_sub_u32 s24, s2, 32
    s_cmp_ge_u32 s24, 32
    s_cbranch_scc1 L_d8
    s_mov_b64 s[24:25], -1
    s_waitcnt lgkmcnt(0)
    s_memtime s[96:97]
    s_waitcnt lgkmcnt(0)
    s_buffer_load_dword s60, s[52:55], s26 offset:0 glc
    s_waitcnt lgkmcnt(0)
    s_memtime s[22:23]
    s_waitcnt lgkmcnt(0)
    s_sub_u32 s3, s22, s96
    s_min_u32 s24, s24, s3
    s_waitcnt lgkmcnt(0)
    s_buffer_load_dword s60, s[52:55], s26 offset:8192 glc
    s_waitcnt lgkmcnt(0)
    s_memtime s[96:97]
    s_waitcnt lgkmcnt(0)
    s_sub_u32 s3, s96, s22
    s_min_u32 s25, s25, s3
    s_cmp_gt_u32 s24, s25
    s_cselect_b32 s3, 2, 0
    s_xor_b32 s3, s3, s36
    s_and_b32 s3, s3, 2
    s_lshl_b32 s3, s3, 15
    s_add_u32 s3, s3, 1
    v_mov_b32 v250, s3
    s_mov_b64 exec, 1
    buffer_atomic_add v250, v244, s[56:59], 0 offen offset:4
    s_mov_b64 exec, -1
L_d8:
    s_mov_b64 exec, 0
    s_cmp_eq_u32 s41, 0
    s_cbranch_scc1 L_chain0
    s_cmp_eq_u32 s41, 1
    s_cbranch_scc1 L_chain1
    s_cmp_eq_u32 s41, 2
    s_cbranch_scc1 L_chain2
    s_branch L_chain3
L_padret0:
    s_mov_b64 exec, -1
    s_mov_b64 exec, 0
    s_cmp_eq_u32 s41, 0
    s_cbranch_scc1 L_chain4
    s_cmp_eq_u32 s41, 1
    s_cbranch_scc1 L_chain5
    s_cmp_eq_u32 s41, 2
    s_cbranch_scc1 L_chain6
    s_branch L_chain7
L_padret1:
    s_mov_b64 exec, -1
    s_branch L_cons
L_load:
    s_setprio 1
    v_mov_b64 v[52:53], 0
    v_mov_b64 v[54:55], 0
    v_mov_b64 v[242:243], 0
    v_mov_b64 v[244:245], 0
    v_mov_b64 v[246:247], 0
    v_mov_b64 v[248:249], 0
    v_bfe_u32 v12, v1, 1, 3
    v_xor_b32 v12, v12, v11
    v_lshlrev_b32 v12, 4, v12
    v_lshl_add_u32 v13, v10, 7, s30
    v_xor_b32 v14, 0, v12
    v_add_u32 v2, v13, v14
    v_xor_b32 v14, 32, v12
    v_add_u32 v3, v13, v14
    v_xor_b32 v14, 64, v12
    v_add_u32 v4, v13, v14
    v_xor_b32 v14, 96, v12
    v_add_u32 v5, v13, v14
    v_add_u32 v12, 0x10000, v2
    v_add_u32 v13, 0x10000, v3
    v_add_u32 v14, 0x10000, v4
    v_add_u32 v15, 0x10000, v5
    s_add_u32 m0, s30, 34816
    s_nop 0
    buffer_load_dwordx4 v18, s[44:47], s32 offen lds
    s_add_u32 m0, s30, 35840
    s_nop 0
    buffer_load_dwordx4 v19, s[44:47], s32 offen lds
    s_mov_b32 s64, 0xffffffff
    s_mov_b32 s65, 0xfffffff0
L_chain0:
L_pad0:
    s_cbranch_execz L_padret0
    s_mov_b32 s66, 0xfffffffe
    s_mov_b32 s67, 0xffffffe0
    s_mov_b32 s68, 0xfffffffc
    s_mov_b32 s69, 0xffffffc0
    s_mov_b32 s70, 0xfffffff8
    s_mov_b32 s71, 0xffffff80
    s_add_u32 m0, s31, 48128
    s_nop 0
    buffer_load_dwordx4 v20, s[48:51], s33 offen offset:1024 lds
    s_mov_b32 s72, 0xffffff00
    s_mov_b32 s73, 0xfffff000
    s_mov_b32 s74, 0xfffffe00
    s_mov_b32 s75, 0xffffe000
    s_mov_b32 s76, 0xfffffc00
    s_mov_b32 s77, 0xffffc000
    s_mov_b32 s78, 0xfffff800
    s_mov_b32 s79, 0xffff8000
    s_add_u32 m0, s31, 49152
    s_nop 0
    buffer_load_dwordx4 v21, s[48:51], s33 offen offset:1024 lds
    s_mov_b32 s80, 0xffff0000
    s_mov_b32 s81, 0xfff00000
    s_mov_b32 s82, 0xfffe0000
    s_mov_b32 s83, 0xffe00000
    s_mov_b32 s84, 0xfffc0000
    s_mov_b32 s85, 0xffc00000
    s_mov_b32 s86, 0xfff80000
    s_mov_b32 s87, 0xff800000
    s_add_u32 m0, s31, 55296
    s_nop 0
    buffer_load_dwordx4 v20, s[48:51], s33 offen offset:2048 lds
    s_mov_b32 s88, 0xff000000
    s_mov_b32 s89, 0xf0000000
    s_mov_b32 s90, 0xfe000000
    s_mov_b32 s91, 0xe0000000
    s_mov_b32 s92, 0xfc000000
    s_mov_b32 s93, 0xc0000000
    s_mov_b32 s94, 0xf8000000
    s_mov_b32 s95, 0x80000000
    s_add_u32 m0, s31, 56320
    s_nop 0
    buffer_load_dwordx4 v21, s[48:51], s33 offen offset:2048 lds
    s_mov_b32 s62, 0x3fb8aa3b
    s_mov_b32 s63, 0x71800000
    s_mov_b32 s28, 0xffff
    s_mov_b32 s29, 0xffff
    v_mov_b32 v240, 0x3f803f80
    v_and_b32 v243, 11, v1
    v_cmp_eq_u32 vcc, 0, v243
    s_nop 1
    v_cndmask_b32 v240, 0, v240, vcc
    s_waitcnt vmcnt(8)
    s_waitcnt lgkmcnt(0)
    s_barrier
    ds_read_b128 v[64:67], v2 offset:0
    ds_read_b128 v[68:71], v3 offset:0
    ds_read_b128 v[72:75], v4 offset:0
    ds_read_b128 v[76:79], v5 offset:0
    s_xor_b32 s32, s26, 256
    s_mul_i32 s33, s32, 1536
    s_add_u32 m0, s31, 80896
    s_nop 0
    buffer_load_dwordx4 v20, s[48:51], s33 offen offset:1024 lds
    v_mov_b32 v241, v240
    v_mov_b32 v243, 0xffff
    v_mov_b64 v[216:217], v[240:241]
    v_mov_b64 v[218:219], v[240:241]
    v_mov_b64 v[220:221], v[240:241]
    v_mov_b64 v[222:223], v[240:241]
    v_mov_b64 v[224:225], v[240:241]
    v_mov_b64 v[226:227], v[240:241]
    s_add_u32 m0, s31, 81920
    s_nop 0
    buffer_load_dwordx4 v21, s[48:51], s33 offen offset:1024 lds
    v_mov_b64 v[228:229], v[240:241]
    v_mov_b64 v[230:231], v[240:241]
    v_cndmask_b32_e64 v232, 0, v243, s[64:65]
    v_cndmask_b32_e64 v233, 0, v243, s[68:69]
    v_cndmask_b32_e64 v234, 0, v243, s[72:73]
    v_cndmask_b32_e64 v235, 0, v243, s[76:77]
    v_cndmask_b32_e64 v236, 0, v243, s[80:81]
    v_cndmask_b32_e64 v237, 0, v243, s[84:85]
    s_add_u32 m0, s31, 88064
    s_nop 0
    buffer_load_dwordx4 v20, s[48:51], s33 offen offset:2048 lds
    v_cndmask_b32_e64 v238, 0, v243, s[88:89]
    v_cndmask_b32_e64 v239, 0, v243, s[92:93]
    v_cndmask_b32_e64 v232, v232, -1, s[66:67]
    v_cndmask_b32_e64 v233, v233, -1, s[70:71]
    v_cndmask_b32_e64 v234, v234, -1, s[74:75]
    v_cndmask_b32_e64 v235, v235, -1, s[78:79]
    v_cndmask_b32_e64 v236, v236, -1, s[82:83]
    v_cndmask_b32_e64 v237, v237, -1, s[86:87]
    s_add_u32 m0, s31, 89088
    s_nop 0
    buffer_load_dwordx4 v21, s[48:51], s33 offen offset:2048 lds
    v_cndmask_b32_e64 v238, v238, -1, s[90:91]
    v_cndmask_b32_e64 v239, v239, -1, s[94:95]
    s_and_b32 s21, s41, 3
    s_lshr_b32 s22, s41, 2
    s_lshl1_add_u32 s20, s22, s38
    s_lshl1_add_u32 s98, s21, s22
    s_lshl_b32 s98, s98, 12
    s_add_u32 s98, s98, 114688
    s_xor_b32 s32, s26, 256
    s_mul_i32 s33, s32, 1536
    s_add_u32 m0, s30, 65536
    s_nop 0
    buffer_load_dwordx4 v16, s[44:47], s32 offen lds
    v_and_b32 v243, 17, v10
    v_cndmask_b32_e64 v242, v243, v10, s[28:29]
    v_and_b32 v243, 7, v242
    v_lshlrev_b32 v248, 2, v11
    v_xor_b32 v243, v243, v248
    v_lshl_add_u32 v242, v242, 3, v243
    v_lshl_add_u32 v242, v242, 4, s98
    v_lshrrev_b32 v248, 3, v1
    s_add_u32 m0, s30, 66560
    s_nop 0
    buffer_load_dwordx4 v17, s[44:47], s32 offen lds
    v_xor_b32 v248, v248, v1
    v_lshlrev_b32 v248, 4, v248
    s_lshl_b32 s24, s21, 10
    s_add_u32 s25, s24, 149504
    v_add_u32 v249, s25, v8
    s_mul_i32 s25, s22, 12288
    s_add_u32 s24, s24, s25
    s_add_u32 s25, s24, 65536
    s_add_u32 m0, s30, 67584
    s_nop 0
    buffer_load_dwordx4 v18, s[44:47], s32 offen lds
    v_add_u32 v245, s25, v8
    v_and_b32 v246, 15, v1
    v_lshlrev_b32 v246, 4, v246
    v_lshl_add_u32 v246, v11, 8, v246
    s_add_u32 s25, s24, 90112
    v_add_u32 v246, s25, v246
    v_lshrrev_b32 v247, 3, v1
    v_and_b32 v244, 7, v1
    s_add_u32 m0, s30, 68608
    s_nop 0
    buffer_load_dwordx4 v19, s[44:47], s32 offen lds
    v_bfe_u32 v243, v1, 4, 1
    v_lshlrev_b32 v243, 2, v243
    v_xor_b32 v244, v244, v243
    v_lshlrev_b32 v244, 4, v244
    v_lshl_add_u32 v247, v247, 10, v244
    v_mov_b32 v243, 1
    v_mov_b32 v244, 0
    v_mov_b64 v[52:53], 0
    s_waitcnt vmcnt(8)
    s_waitcnt lgkmcnt(0)
    s_barrier
    ds_read_b128 v[80:83], v2 offset:32768
    ds_read_b128 v[84:87], v3 offset:32768
    ds_read_b128 v[88:91], v4 offset:32768
    ds_read_b128 v[92:95], v5 offset:32768
    s_xor_b32 s32, s26, 384
    s_mul_i32 s33, s32, 1536
    s_add_u32 m0, s30, 98304
    s_nop 0
    buffer_load_dwordx4 v16, s[44:47], s32 offen lds
    v_mov_b64 v[54:55], 0
    s_lshl_b32 s4, s39, 2
    s_add_u32 s4, s4, s21
    s_lshr_b32 s23, s37, 2
    s_lshl_b32 s23, s23, 7
    v_add_u32 v247, s23, v247
    s_and_b32 s24, s37, 3
    s_lshl_b32 s24, s24, 4
    s_add_u32 m0, s30, 99328
    s_nop 0
    buffer_load_dwordx4 v17, s[44:47], s32 offen lds
    s_add_u32 s24, s24, s21
    s_lshl_b32 s5, s24, 10
    s_lshl_b32 s24, s40, 1
    s_add_u32 s24, s24, s22
    s_mul_i32 s6, s24, 2048
    s_add_u32 s6, s6, 17825792
    s_lshl_b32 s24, s21, 1
    s_add_u32 s24, s24, s22
    s_add_u32 m0, s30, 100352
    s_nop 0
    buffer_load_dwordx4 v18, s[44:47], s32 offen lds
    s_lshl_b32 s13, s24, 15
    s_add_u32 s13, s13, 4194304
    s_lshl_b32 s24, s24, 7
    s_add_u32 s12, s24, 20975616
    s_lshl4_add_u32 s24, s38, s35
    s_lshl_b32 s24, s24, 10
    s_lshl_b32 s25, s39, 18
    s_add_u32 s24, s24, s25
    s_add_u32 m0, s30, 101376
    s_nop 0
    buffer_load_dwordx4 v19, s[44:47], s32 offen lds
    s_add_u32 s7, s24, s13
    s_add_u32 s8, s12, s25
    s_lshl_b32 s24, s35, 15
    s_add_u32 s25, s25, s24
    s_and_b32 s24, s21, 2
    s_add_u32 s24, s24, s21
    s_add_u32 s24, s24, s24
    s_and_b32 s24, s24, 10
    s_add_u32 m0, s31, 113664
    s_nop 0
    buffer_load_dwordx4 v20, s[48:51], s33 offen offset:1024 lds
    s_lshl_b32 s24, s24, 11
    s_add_u32 s25, s25, s24
    s_and_b32 s24, s35, 1
    s_lshl_b32 s24, s24, 10
    s_add_u32 s25, s25, s24
    s_mul_i32 s24, s38, 2105344
    s_add_u32 s25, s25, s24
    s_add_u32 s15, s25, 8388608
    s_add_u32 m0, s31, 114688
    s_nop 0
    buffer_load_dwordx4 v21, s[48:51], s33 offen offset:1024 lds
    s_and_b32 s24, s39, 12
    s_xor_b32 s24, s24, 4
    s_and_b32 s25, s37, 3
    s_add_u32 s24, s24, s25
    s_lshr_b32 s22, s36, 2
    s_lshl_b32 s14, s24, 18
    s_add_u32 s12, s12, s14
    s_add_u32 s13, s13, s14
    s_waitcnt vmcnt(6)
    s_waitcnt lgkmcnt(0)
    s_barrier
    ds_read_b128 v[96:99], v12 offset:0
    ds_read_b128 v[100:103], v13 offset:0
    ds_read_b128 v[104:107], v14 offset:0
    ds_read_b128 v[108:111], v15 offset:0
    s_add_u32 m0, s31, 120832
    s_nop 0
    buffer_load_dwordx4 v20, s[48:51], s33 offen offset:2048 lds
    s_mul_i32 s25, s22, 2105344
    s_add_u32 s13, s13, s25
    s_lshl_b32 s25, s22, 10
    s_add_u32 s12, s12, s25
    s_add_u32 s14, s14, s25
    s_lshl_b32 s25, s21, 16
    s_add_u32 s14, s14, s25
    s_add_u32 s14, s14, s23
    s_add_u32 m0, s31, 121856
    s_nop 0
    buffer_load_dwordx4 v21, s[48:51], s33 offen offset:2048 lds
    v_bfe_u32 v6, v1, 2, 2
    v_lshl_add_u32 v6, v11, 3, v6
    v_lshlrev_b32 v6, 7, v6
    v_bfe_u32 v7, v1, 3, 1
    v_xor_b32 v7, s38, v7
    v_lshl_add_u32 v6, v7, 6, v6
    v_bfe_u32 v7, v1, 4, 1
    v_xor_b32 v7, v7, v11
    s_xor_b32 s32, s26, 512
    s_mul_i32 s33, s32, 1536
    s_add_u32 m0, s30, 0
    s_nop 0
    buffer_load_dwordx4 v16, s[44:47], s32 offen lds
    v_lshl_add_u32 v6, v7, 5, v6
    v_and_b32 v7, 3, v1
    v_lshl_add_u32 v7, v7, 3, v6
    v_xor_b32 v6, 64, v7
    s_mul_i32 s9, s38, 4210688
    s_sub_u32 s9, 2105344, s9
    s_add_u32 s9, s9, s15
    s_add_u32 m0, s30, 1024
    s_nop 0
    buffer_load_dwordx4 v17, s[44:47], s32 offen lds
    s_add_u32 m0, s30, 2048
    s_nop 0
    buffer_load_dwordx4 v18, s[44:47], s32 offen lds
    s_add_u32 m0, s30, 3072
    s_nop 0
    buffer_load_dwordx4 v19, s[44:47], s32 offen lds
    s_add_u32 m0, s31, 15360
    s_nop 0
    buffer_load_dwordx4 v20, s[48:51], s33 offen offset:1024 lds
    s_add_u32 m0, s31, 16384
    s_nop 0
    buffer_load_dwordx4 v21, s[48:51], s33 offen offset:1024 lds
    s_waitcnt vmcnt(6)
    s_waitcnt lgkmcnt(0)
    s_barrier
    ds_read_b128 v[112:115], v12 offset:32768
    ds_read_b128 v[116:119], v13 offset:32768
    ds_read_b128 v[120:123], v14 offset:32768
    ds_read_b128 v[124:127], v15 offset:32768
    s_add_u32 m0, s31, 22528
    s_nop 0
    buffer_load_dwordx4 v20, s[48:51], s33 offen offset:2048 lds
    s_add_u32 m0, s31, 23552
    s_nop 0
    buffer_load_dwordx4 v21, s[48:51], s33 offen offset:2048 lds
    s_xor_b32 s32, s26, 640
    s_mul_i32 s33, s32, 1536
    s_add_u32 m0, s30, 32768
    s_nop 0
    buffer_load_dwordx4 v16, s[44:47], s32 offen lds
    s_add_u32 m0, s30, 33792
    s_nop 0
    buffer_load_dwordx4 v17, s[44:47], s32 offen lds
    s_add_u32 m0, s30, 34816
    s_nop 0
    buffer_load_dwordx4 v18, s[44:47], s32 offen lds
    s_add_u32 m0, s30, 35840
    s_nop 0
    buffer_load_dwordx4 v19, s[44:47], s32 offen lds
    s_waitcnt vmcnt(4)
    s_waitcnt lgkmcnt(0)
    s_barrier
    ds_read_b128 v[128:131], v2 offset:0
    ds_read_b128 v[132:135], v3 offset:0
    ds_read_b128 v[136:139], v4 offset:0
    ds_read_b128 v[140:143], v5 offset:0
    s_add_u32 m0, s31, 48128
    s_nop 0
    buffer_load_dwordx4 v20, s[48:51], s33 offen offset:1024 lds
    s_add_u32 m0, s31, 49152
    s_nop 0
    buffer_load_dwordx4 v21, s[48:51], s33 offen offset:1024 lds
    s_add_u32 m0, s31, 55296
    s_nop 0
    buffer_load_dwordx4 v20, s[48:51], s33 offen offset:2048 lds
    s_add_u32 m0, s31, 56320
    s_nop 0
    buffer_load_dwordx4 v21, s[48:51], s33 offen offset:2048 lds
    s_xor_b32 s32, s26, 768
    s_mul_i32 s33, s32, 1536
    s_add_u32 m0, s30, 65536
    s_nop 0
    buffer_load_dwordx4 v16, s[44:47], s32 offen lds
    s_add_u32 m0, s30, 66560
    s_nop 0
    buffer_load_dwordx4 v17, s[44:47], s32 offen lds
    s_add_u32 m0, s30, 67584
    s_nop 0
    buffer_load_dwordx4 v18, s[44:47], s32 offen lds
    s_add_u32 m0, s30, 68608
    s_nop 0
    buffer_load_dwordx4 v19, s[44:47], s32 offen lds
    s_add_u32 m0, s31, 80896
    s_nop 0
    buffer_load_dwordx4 v20, s[48:51], s33 offen offset:1024 lds
    s_add_u32 m0, s31, 81920
    s_nop 0
    buffer_load_dwordx4 v21, s[48:51], s33 offen offset:1024 lds
    s_add_u32 m0, s31, 88064
    s_nop 0
    buffer_load_dwordx4 v20, s[48:51], s33 offen offset:2048 lds
    s_add_u32 m0, s31, 89088
    s_nop 0
    buffer_load_dwordx4 v21, s[48:51], s33 offen offset:2048 lds
    s_waitcnt vmcnt(8)
    s_waitcnt lgkmcnt(0)
    s_barrier
    ds_read_b128 v[144:147], v2 offset:32768
    ds_read_b128 v[148:151], v3 offset:32768
    ds_read_b128 v[152:155], v4 offset:32768
    ds_read_b128 v[156:159], v5 offset:32768
    s_buffer_load_dwordx2 s[60:61], s[56:59], 0
    s_xor_b32 s32, s26, 896
    s_mul_i32 s33, s32, 1536
    s_add_u32 m0, s30, 98304
    s_nop 0
    buffer_load_dwordx4 v16, s[44:47], s32 offen lds
    s_add_u32 m0, s30, 99328
    s_nop 0
    buffer_load_dwordx4 v17, s[44:47], s32 offen lds
    s_add_u32 m0, s30, 100352
    s_nop 0
    buffer_load_dwordx4 v18, s[44:47], s32 offen lds
    s_add_u32 m0, s30, 101376
    s_nop 0
    buffer_load_dwordx4 v19, s[44:47], s32 offen lds
    s_add_u32 m0, s31, 113664
    s_nop 0
    buffer_load_dwordx4 v20, s[48:51], s33 offen offset:1024 lds
    s_add_u32 m0, s31, 114688
    s_nop 0
    buffer_load_dwordx4 v21, s[48:51], s33 offen offset:1024 lds
    s_add_u32 m0, s31, 120832
    s_nop 0
    buffer_load_dwordx4 v20, s[48:51], s33 offen offset:2048 lds
    s_add_u32 m0, s31, 121856
    s_nop 0
    buffer_load_dwordx4 v21, s[48:51], s33 offen offset:2048 lds
    s_waitcnt vmcnt(8)
    s_waitcnt lgkmcnt(0)
    s_barrier
    ds_read_b128 v[160:163], v12 offset:0
    ds_read_b128 v[164:167], v13 offset:0
    ds_read_b128 v[168:171], v14 offset:0
    ds_read_b128 v[172:175], v15 offset:0
    s_and_b32 s24, s61, 0xffff
    s_cmp_lg_u32 s60, 0
    s_cselect_b32 s24, s24, 0
    s_cmp_lt_u32 s24, 64
    s_cbranch_scc1 L_tgw
L_tgd:
    v_mov_b32 v22, 149376
    v_mov_b32 v24, s60
    v_mov_b32 v25, s61
    ds_write_b64 v22, v[24:25]
    s_lshr_b32 s24, s61, 14
    s_and_b32 s61, s61, 0xffff
    s_cmp_le_u32 s24, s61
    s_cbranch_scc1 L_pll
    s_add_u32 s52, s52, 8192
    s_addc_u32 s53, s53, 0
    s_sub_u32 s6, s6, 8192
L_pll:
    s_add_u32 s24, s39, s35
    s_and_b32 s24, s24, 2
    s_lshl_b32 s25, s24, 7
    s_xor_b32 s26, s26, s25
    s_lshl_b32 s25, s24, 13
    s_xor_b32 s31, s31, s25
    s_xor_b32 s32, s26, 0
    s_mul_i32 s33, s32, 1536
    s_xor_b32 m0, s31, 0
    s_nop 0
    buffer_load_dwordx4 v20, s[48:51], s33 offen lds
    s_xor_b32 m0, s31, 1024
    s_nop 0
    buffer_load_dwordx4 v21, s[48:51], s33 offen lds
    s_xor_b32 s32, s26, 128
    s_mul_i32 s33, s32, 1536
    s_xor_b32 m0, s31, 8192
    s_nop 0
    buffer_load_dwordx4 v20, s[48:51], s33 offen lds
    s_xor_b32 m0, s31, 9216
    s_nop 0
    buffer_load_dwordx4 v21, s[48:51], s33 offen lds
    s_xor_b32 s32, s26, 256
    s_mul_i32 s33, s32, 1536
    s_xor_b32 m0, s31, 16384
    s_nop 0
    buffer_load_dwordx4 v20, s[48:51], s33 offen lds
    s_xor_b32 m0, s31, 17408
    s_nop 0
    buffer_load_dwordx4 v21, s[48:51], s33 offen lds
    s_xor_b32 s32, s26, 384
    s_mul_i32 s33, s32, 1536
    s_xor_b32 m0, s31, 24576
    s_nop 0
    buffer_load_dwordx4 v20, s[48:51], s33 offen lds
    s_xor_b32 m0, s31, 25600
    s_nop 0
    buffer_load_dwordx4 v21, s[48:51], s33 offen lds
    s_waitcnt vmcnt(8)
    s_waitcnt lgkmcnt(0)
    s_barrier
    ds_read_b128 v[176:179], v12 offset:32768
    ds_read_b128 v[180:183], v13 offset:32768
    ds_read_b128 v[184:187], v14 offset:32768
    ds_read_b128 v[188:191], v15 offset:32768
    s_add_u32 s24, s2, s60
    s_and_b32 s24, s24, 7
    s_cmp_lg_u32 s24, s99
    s_cbranch_scc1 L_wrong
    s_waitcnt lgkmcnt(0)
    s_barrier
    s_xor_b32 s32, s26, 512
    s_mul_i32 s33, s32, 1536
    s_xor_b32 m0, s31, 32768
    s_nop 0
    buffer_load_dwordx4 v20, s[48:51], s33 offen lds
    s_xor_b32 m0, s31, 33792
    s_nop 0
    buffer_load_dwordx4 v21, s[48:51], s33 offen lds
    s_xor_b32 s32, s26, 640
    s_mul_i32 s33, s32, 1536
    s_xor_b32 m0, s31, 40960
    s_nop 0
    buffer_load_dwordx4 v20, s[48:51], s33 offen lds
    s_xor_b32 m0, s31, 41984
    s_nop 0
    buffer_load_dwordx4 v21, s[48:51], s33 offen lds
    s_xor_b32 s32, s26, 768
    s_mul_i32 s33, s32, 1536
    s_xor_b32 m0, s31, 49152
    s_nop 0
    buffer_load_dwordx4 v20, s[48:51], s33 offen lds
    s_xor_b32 m0, s31, 50176
    s_nop 0
    buffer_load_dwordx4 v21, s[48:51], s33 offen lds
    s_xor_b32 s32, s26, 896
    s_mul_i32 s33, s32, 1536
    s_xor_b32 m0, s31, 57344
    s_nop 0
    buffer_load_dwordx4 v20, s[48:51], s33 offen lds
    s_xor_b32 m0, s31, 58368
    s_nop 0
    buffer_load_dwordx4 v21, s[48:51], s33 offen lds
    s_cmp_lt_u32 s36, 4
    s_cselect_b32 s44, s10, s16
    s_cselect_b32 s45, s11, s17
    s_mov_b32 s46, 0x80000
    s_mov_b32 s47, 0x20000
    s_cmp_eq_u32 s38, 0
    s_cselect_b32 s27, 0x3eb8aa3b, 1.0
    s_waitcnt vmcnt(8)
    v_mov_b32 v22, 149376
    s_mov_b64 exec, 1
    ds_add_u32 v22, v243 offset:12
    s_mov_b64 exec, -1
    v_mov_b32 v22, 149376
    s_mov_b32 s3, 262144
L_sp1:
    s_sub_u32 s3, s3, 1
    ds_read_b32 v23, v22 offset:12
    s_waitcnt lgkmcnt(0)
    v_cmp_gt_u32 vcc, 4, v23
    s_cselect_b64 vcc, 0, vcc
    s_cbranch_vccnz L_sp1
    s_setprio 0
    s_cmp_eq_u32 s38, 1
    s_cbranch_scc1 L_noprio
    s_setprio 1
L_noprio:
    ds_read_b64_tr_b16 v[192:193], v6 offset:0
    ds_read_b64_tr_b16 v[194:195], v6 offset:512
    ds_read_b64_tr_b16 v[196:197], v6 offset:2048
    ds_read_b64_tr_b16 v[198:199], v6 offset:2560
    ds_read_b64_tr_b16 v[200:201], v6 offset:4096
    ds_read_b64_tr_b16 v[202:203], v6 offset:4608
    ds_read_b64_tr_b16 v[204:205], v6 offset:6144
    ds_read_b64_tr_b16 v[206:207], v6 offset:6656
    ds_read_b64_tr_b16 v[208:209], v6 offset:8192
    ds_read_b64_tr_b16 v[210:211], v6 offset:8704
    s_waitcnt lgkmcnt(8)
    v_mfma_f32_32x32x16_bf16 v[32:47], v[192:195], v[64:67], 0
    ds_read_b64_tr_b16 v[212:213], v6 offset:10240
    ds_read_b64_tr_b16 v[214:215], v6 offset:10752
    s_waitcnt lgkmcnt(8)
    v_mfma_f32_32x32x16_bf16 v[32:47], v[196:199], v[68:71], v[32:47]
    ds_read_b64_tr_b16 v[192:193], v6 offset:12288
    ds_read_b64_tr_b16 v[194:195], v6 offset:12800
    s_waitcnt lgkmcnt(8)
    v_mfma_f32_32x32x16_bf16 v[32:47], v[200:203], v[72:75], v[32:47]
    ds_read_b64_tr_b16 v[196:197], v6 offset:14336
    ds_read_b64_tr_b16 v[198:199], v6 offset:14848
    s_waitcnt lgkmcnt(8)
    v_mfma_f32_32x32x16_bf16 v[32:47], v[204:207], v[76:79], v[32:47]
    ds_read_b64_tr_b16 v[200:201], v6 offset:16384
    ds_read_b64_tr_b16 v[202:203], v6 offset:16896
    s_waitcnt lgkmcnt(8)
    v_mfma_f32_32x32x16_bf16 v[32:47], v[208:211], v[80:83], v[32:47]
    ds_read_b64_tr_b16 v[204:205], v6 offset:18432
    ds_read_b64_tr_b16 v[206:207], v6 offset:18944
    s_waitcnt lgkmcnt(8)
    v_mfma_f32_32x32x16_bf16 v[32:47], v[212:215], v[84:87], v[32:47]
    ds_read_b64_tr_b16 v[208:209], v6 offset:20480
    ds_read_b64_tr_b16 v[210:211], v6 offset:20992
    s_waitcnt lgkmcnt(8)
    v_mfma_f32_32x32x16_bf16 v[32:47], v[192:195], v[88:91], v[32:47]
    ds_read_b64_tr_b16 v[212:213], v6 offset:22528
    ds_read_b64_tr_b16 v[214:215], v6 offset:23040
    s_waitcnt lgkmcnt(8)
    v_mfma_f32_32x32x16_bf16 v[32:47], v[196:199], v[92:95], v[32:47]
    s_waitcnt vmcnt(0)
    v_mov_b32 v22, 149376
    s_mov_b64 exec, 1
    ds_add_u32 v22, v243 offset:28
    s_mov_b64 exec, -1
    ds_read_b64_tr_b16 v[192:193], v6 offset:24576
    ds_read_b64_tr_b16 v[194:195], v6 offset:25088
    s_waitcnt lgkmcnt(9)
    v_mfma_f32_32x32x16_bf16 v[32:47], v[200:203], v[96:99], v[32:47]
    ds_read_b64_tr_b16 v[196:197], v6 offset:26624
    ds_read_b64_tr_b16 v[198:199], v6 offset:27136
    s_waitcnt lgkmcnt(9)
    v_mfma_f32_32x32x16_bf16 v[32:47], v[204:207], v[100:103], v[32:47]
    ds_read_b64_tr_b16 v[200:201], v6 offset:28672
    ds_read_b64_tr_b16 v[202:203], v6 offset:29184
    s_waitcnt lgkmcnt(9)
    v_mfma_f32_32x32x16_bf16 v[32:47], v[208:211], v[104:107], v[32:47]
    ds_read_b64_tr_b16 v[204:205], v6 offset:30720
    ds_read_b64_tr_b16 v[206:207], v6 offset:31232
    s_waitcnt lgkmcnt(9)
    v_mfma_f32_32x32x16_bf16 v[32:47], v[212:215], v[108:111], v[32:47]
    v_mov_b32 v22, 149376
    s_mov_b32 s3, 262144
L_sp2:
    s_sub_u32 s3, s3, 1
    ds_read_b32 v23, v22 offset:28
    s_waitcnt lgkmcnt(0)
    v_cmp_gt_u32 vcc, 4, v23
    s_cselect_b64 vcc, 0, vcc
    s_cbranch_vccnz L_sp2
    ds_read_b64_tr_b16 v[208:209], v6 offset:32768
    ds_read_b64_tr_b16 v[210:211], v6 offset:33280
    v_mfma_f32_32x32x16_bf16 v[32:47], v[192:195], v[112:115], v[32:47]
    ds_read_b64_tr_b16 v[212:213], v6 offset:34816
    ds_read_b64_tr_b16 v[214:215], v6 offset:35328
    v_mfma_f32_32x32x16_bf16 v[32:47], v[196:199], v[116:119], v[32:47]
    ds_read_b64_tr_b16 v[192:193], v6 offset:36864
    ds_read_b64_tr_b16 v[194:195], v6 offset:37376
    v_mfma_f32_32x32x16_bf16 v[32:47], v[200:203], v[120:123], v[32:47]
    ds_read_b64_tr_b16 v[196:197], v6 offset:38912
    ds_read_b64_tr_b16 v[198:199], v6 offset:39424
    v_mfma_f32_32x32x16_bf16 v[32:47], v[204:207], v[124:127], v[32:47]
    ds_read_b64_tr_b16 v[200:201], v6 offset:40960
    ds_read_b64_tr_b16 v[202:203], v6 offset:41472
    s_waitcnt lgkmcnt(8)
    v_mfma_f32_32x32x16_bf16 v[32:47], v[208:211], v[128:131], v[32:47]
    ds_read_b64_tr_b16 v[204:205], v6 offset:43008
    ds_read_b64_tr_b16 v[206:207], v6 offset:43520
    s_waitcnt lgkmcnt(8)
    v_mfma_f32_32x32x16_bf16 v[32:47], v[212:215], v[132:135], v[32:47]
    ds_read_b64_tr_b16 v[208:209], v6 offset:45056
    ds_read_b64_tr_b16 v[210:211], v6 offset:45568
    s_waitcnt lgkmcnt(8)
    v_mfma_f32_32x32x16_bf16 v[32:47], v[192:195], v[136:139], v[32:47]
    ds_read_b64_tr_b16 v[212:213], v6 offset:47104
    ds_read_b64_tr_b16 v[214:215], v6 offset:47616
    s_waitcnt lgkmcnt(8)
    v_mfma_f32_32x32x16_bf16 v[32:47], v[196:199], v[140:143], v[32:47]
    ds_read_b64_tr_b16 v[192:193], v6 offset:49152
    ds_read_b64_tr_b16 v[194:195], v6 offset:49664
    s_waitcnt lgkmcnt(8)
    v_mfma_f32_32x32x16_bf16 v[32:47], v[200:203], v[144:147], v[32:47]
    ds_read_b64_tr_b16 v[196:197], v6 offset:51200
    ds_read_b64_tr_b16 v[198:199], v6 offset:51712
    v_mov_b32 v19, s60
    v_mov_b32 v23, s60
    v_mov_b32 v26, s60
    v_mov_b32 v27, s60
    s_waitcnt lgkmcnt(8)
    v_mfma_f32_32x32x16_bf16 v[32:47], v[204:207], v[148:151], v[32:47]
    ds_read_b64_tr_b16 v[200:201], v6 offset:53248
    ds_read_b64_tr_b16 v[202:203], v6 offset:53760
    s_waitcnt lgkmcnt(8)
    v_mfma_f32_32x32x16_bf16 v[32:47], v[208:211], v[152:155], v[32:47]
    ds_read_b64_tr_b16 v[204:205], v6 offset:55296
    ds_read_b64_tr_b16 v[206:207], v6 offset:55808
    s_waitcnt lgkmcnt(8)
    v_mfma_f32_32x32x16_bf16 v[32:47], v[212:215], v[156:159], v[32:47]
    ds_read_b64_tr_b16 v[208:209], v6 offset:57344
    ds_read_b64_tr_b16 v[210:211], v6 offset:57856
    s_waitcnt lgkmcnt(8)
    v_mfma_f32_32x32x16_bf16 v[32:47], v[192:195], v[160:163], v[32:47]
    ds_read_b64_tr_b16 v[212:213], v6 offset:59392
    ds_read_b64_tr_b16 v[214:215], v6 offset:59904
    s_waitcnt lgkmcnt(8)
    v_mfma_f32_32x32x16_bf16 v[32:47], v[196:199], v[164:167], v[32:47]
    ds_read_b64_tr_b16 v[192:193], v6 offset:61440
    ds_read_b64_tr_b16 v[194:195], v6 offset:61952
    s_waitcnt lgkmcnt(8)
L_chain1:
L_pad1:
    s_cbranch_execz L_padret0
    v_mfma_f32_32x32x16_bf16 v[32:47], v[200:203], v[168:171], v[32:47]
    ds_read_b64_tr_b16 v[196:197], v6 offset:63488
    ds_read_b64_tr_b16 v[198:199], v6 offset:64000
    s_waitcnt lgkmcnt(8)
    v_mfma_f32_32x32x16_bf16 v[32:47], v[204:207], v[172:175], v[32:47]
    ds_read_b64_tr_b16 v[200:201], v7 offset:0
    ds_read_b64_tr_b16 v[202:203], v7 offset:512
    s_waitcnt lgkmcnt(8)
    v_mfma_f32_32x32x16_bf16 v[32:47], v[208:211], v[176:179], v[32:47]
    ds_read_b64_tr_b16 v[204:205], v7 offset:2048
    ds_read_b64_tr_b16 v[206:207], v7 offset:2560
    s_waitcnt lgkmcnt(8)
    v_mfma_f32_32x32x16_bf16 v[32:47], v[212:215], v[180:183], v[32:47]
    ds_read_b64_tr_b16 v[208:209], v7 offset:4096
    ds_read_b64_tr_b16 v[210:211], v7 offset:4608
    s_waitcnt lgkmcnt(8)
    v_mfma_f32_32x32x16_bf16 v[32:47], v[192:195], v[184:187], v[32:47]
    ds_read_b64_tr_b16 v[212:213], v7 offset:6144
    ds_read_b64_tr_b16 v[214:215], v7 offset:6656
    s_waitcnt lgkmcnt(8)
    v_mfma_f32_32x32x16_bf16 v[32:47], v[196:199], v[188:191], v[32:47]
    ds_read_b64_tr_b16 v[192:193], v7 offset:8192
    ds_read_b64_tr_b16 v[194:195], v7 offset:8704
    s_waitcnt lgkmcnt(8)
    v_mfma_f32_32x32x16_bf16 v[48:63], v[200:203], v[64:67], 0
    ds_read_b64_tr_b16 v[196:197], v7 offset:10240
    ds_read_b64_tr_b16 v[198:199], v7 offset:10752
    s_nop 5
    v_mul_f32 v32, s27, v32
    v_mul_f32 v33, s27, v33
    v_mul_f32 v34, s27, v34
    v_mul_f32 v35, s27, v35
    v_mul_f32 v36, s27, v36
    v_mul_f32 v37, s27, v37
    v_cvt_pk_bf16_f32 v16, v32, v33
    v_cvt_pk_bf16_f32 v17, v34, v35
    v_cvt_pk_bf16_f32 v18, v36, v37
    buffer_store_dwordx4 v[16:19], v8, s[52:55], s9 offen offset:0 sc1
    v_mul_f32 v38, s27, v38
    v_mul_f32 v39, s27, v39
    v_mul_f32 v40, s27, v40
    v_mul_f32 v41, s27, v41
    v_mul_f32 v42, s27, v42
    v_mul_f32 v43, s27, v43
    v_cvt_pk_bf16_f32 v20, v38, v39
    v_cvt_pk_bf16_f32 v21, v40, v41
    v_cvt_pk_bf16_f32 v22, v42, v43
    buffer_store_dwordx4 v[20:23], v8, s[52:55], s9 offen offset:1024 sc1
    v_mul_f32 v44, s27, v44
    v_mul_f32 v45, s27, v45
    v_mul_f32 v46, s27, v46
    v_mul_f32 v47, s27, v47
    v_cvt_pk_bf16_f32 v24, v44, v45
    v_cvt_pk_bf16_f32 v25, v46, v47
    buffer_store_dwordx4 v[24:27], v8, s[52:55], s9 offen offset:2048 sc1
    s_waitcnt lgkmcnt(8)
    v_mfma_f32_32x32x16_bf16 v[48:63], v[204:207], v[68:71], v[48:63]
    ds_read_b64_tr_b16 v[200:201], v7 offset:12288
    ds_read_b64_tr_b16 v[202:203], v7 offset:12800
    s_waitcnt lgkmcnt(8)
    v_mfma_f32_32x32x16_bf16 v[48:63], v[208:211], v[72:75], v[48:63]
    ds_read_b64_tr_b16 v[204:205], v7 offset:14336
    ds_read_b64_tr_b16 v[206:207], v7 offset:14848
    s_waitcnt lgkmcnt(8)
    v_mfma_f32_32x32x16_bf16 v[48:63], v[212:215], v[76:79], v[48:63]
    ds_read_b64_tr_b16 v[208:209], v7 offset:16384
    ds_read_b64_tr_b16 v[210:211], v7 offset:16896
    s_waitcnt lgkmcnt(8)
    v_mfma_f32_32x32x16_bf16 v[48:63], v[192:195], v[80:83], v[48:63]
    ds_read_b64_tr_b16 v[212:213], v7 offset:18432
    ds_read_b64_tr_b16 v[214:215], v7 offset:18944
    s_waitcnt lgkmcnt(8)
    v_mfma_f32_32x32x16_bf16 v[48:63], v[196:199], v[84:87], v[48:63]
    ds_read_b64_tr_b16 v[192:193], v7 offset:20480
    ds_read_b64_tr_b16 v[194:195], v7 offset:20992
    s_waitcnt lgkmcnt(8)
    v_mfma_f32_32x32x16_bf16 v[48:63], v[200:203], v[88:91], v[48:63]
    ds_read_b64_tr_b16 v[196:197], v7 offset:22528
    ds_read_b64_tr_b16 v[198:199], v7 offset:23040
    s_waitcnt lgkmcnt(8)
    v_mfma_f32_32x32x16_bf16 v[48:63], v[204:207], v[92:95], v[48:63]
    ds_read_b64_tr_b16 v[200:201], v7 offset:24576
    ds_read_b64_tr_b16 v[202:203], v7 offset:25088
    s_waitcnt lgkmcnt(8)
    v_mfma_f32_32x32x16_bf16 v[48:63], v[208:211], v[96:99], v[48:63]
    ds_read_b64_tr_b16 v[204:205], v7 offset:26624
    ds_read_b64_tr_b16 v[206:207], v7 offset:27136
    s_waitcnt lgkmcnt(8)
    v_mfma_f32_32x32x16_bf16 v[48:63], v[212:215], v[100:103], v[48:63]
    ds_read_b64_tr_b16 v[208:209], v7 offset:28672
    ds_read_b64_tr_b16 v[210:211], v7 offset:29184
    s_waitcnt lgkmcnt(8)
    v_mfma_f32_32x32x16_bf16 v[48:63], v[192:195], v[104:107], v[48:63]
    ds_read_b64_tr_b16 v[212:213], v7 offset:30720
    ds_read_b64_tr_b16 v[214:215], v7 offset:31232
    s_waitcnt lgkmcnt(8)
    v_mfma_f32_32x32x16_bf16 v[48:63], v[196:199], v[108:111], v[48:63]
    ds_read_b64_tr_b16 v[192:193], v7 offset:32768
    ds_read_b64_tr_b16 v[194:195], v7 offset:33280
    s_waitcnt lgkmcnt(8)
    v_mfma_f32_32x32x16_bf16 v[48:63], v[200:203], v[112:115], v[48:63]
    ds_read_b64_tr_b16 v[196:197], v7 offset:34816
    ds_read_b64_tr_b16 v[198:199], v7 offset:35328
    v_bfe_u32 v15, v1, 2, 2
    v_lshl_add_u32 v15, v11, 2, v15
    v_lshlrev_b32 v15, 5, v15
    v_and_b32 v14, 3, v1
    v_lshl_add_u32 v15, v14, 3, v15
    s_lshl_b32 s24, s38, 10
    s_add_u32 s24, s24, 161792
    v_add_u32 v15, s24, v15
    s_waitcnt lgkmcnt(8)
    v_mfma_f32_32x32x16_bf16 v[48:63], v[204:207], v[116:119], v[48:63]
    ds_read_b64_tr_b16 v[200:201], v7 offset:36864
    ds_read_b64_tr_b16 v[202:203], v7 offset:37376
    s_waitcnt lgkmcnt(8)
    v_mfma_f32_32x32x16_bf16 v[48:63], v[208:211], v[120:123], v[48:63]
    ds_read_b64_tr_b16 v[204:205], v7 offset:38912
    ds_read_b64_tr_b16 v[206:207], v7 offset:39424
    ds_read_b64_tr_b16 v[16:17], v15 offset:0
    ds_read_b64_tr_b16 v[18:19], v15 offset:256
    ds_read_b64_tr_b16 v[20:21], v15 offset:512
    ds_read_b64_tr_b16 v[22:23], v15 offset:768
    s_waitcnt lgkmcnt(12)
    v_mfma_f32_32x32x16_bf16 v[48:63], v[212:215], v[124:127], v[48:63]
    ds_read_b64_tr_b16 v[208:209], v7 offset:40960
    ds_read_b64_tr_b16 v[210:211], v7 offset:41472
    s_waitcnt lgkmcnt(12)
    v_mfma_f32_32x32x16_bf16 v[48:63], v[192:195], v[128:131], v[48:63]
    ds_read_b64_tr_b16 v[212:213], v7 offset:43008
    ds_read_b64_tr_b16 v[214:215], v7 offset:43520
    s_waitcnt lgkmcnt(12)
    v_mfma_f32_32x32x16_bf16 v[48:63], v[196:199], v[132:135], v[48:63]
    ds_read_b64_tr_b16 v[192:193], v7 offset:45056
    ds_read_b64_tr_b16 v[194:195], v7 offset:45568
    s_waitcnt lgkmcnt(12)
    v_mfma_f32_32x32x16_bf16 v[48:63], v[200:203], v[136:139], v[48:63]
    ds_read_b64_tr_b16 v[196:197], v7 offset:47104
    ds_read_b64_tr_b16 v[198:199], v7 offset:47616
    s_waitcnt lgkmcnt(12)
    v_mfma_f32_32x32x16_bf16 v[48:63], v[204:207], v[140:143], v[48:63]
    ds_read_b64_tr_b16 v[200:201], v7 offset:49152
    ds_read_b64_tr_b16 v[202:203], v7 offset:49664
    s_waitcnt lgkmcnt(8)
    v_mfma_f32_32x32x16_bf16 v[48:63], v[208:211], v[144:147], v[48:63]
    ds_read_b64_tr_b16 v[204:205], v7 offset:51200
    ds_read_b64_tr_b16 v[206:207], v7 offset:51712
    s_waitcnt lgkmcnt(8)
    v_mfma_f32_32x32x16_bf16 v[48:63], v[212:215], v[148:151], v[48:63]
    ds_read_b64_tr_b16 v[208:209], v7 offset:53248
    ds_read_b64_tr_b16 v[210:211], v7 offset:53760
    s_waitcnt lgkmcnt(8)
    v_mfma_f32_32x32x16_bf16 v[48:63], v[192:195], v[152:155], v[48:63]
    ds_read_b64_tr_b16 v[212:213], v7 offset:55296
    ds_read_b64_tr_b16 v[214:215], v7 offset:55808
    s_waitcnt lgkmcnt(8)
    v_mfma_f32_32x32x16_bf16 v[48:63], v[196:199], v[156:159], v[48:63]
    ds_read_b64_tr_b16 v[192:193], v7 offset:57344
    ds_read_b64_tr_b16 v[194:195], v7 offset:57856
    s_waitcnt lgkmcnt(8)
    v_mfma_f32_32x32x16_bf16 v[48:63], v[200:203], v[160:163], v[48:63]
    ds_read_b64_tr_b16 v[196:197], v7 offset:59392
    ds_read_b64_tr_b16 v[198:199], v7 offset:59904
    s_cmp_eq_u32 s38, 0
    s_cbranch_scc1 L_noqp56
    buffer_load_dwordx4 v[32:35], v8, s[52:55], s15 offen offset:0 sc1
    buffer_load_dwordx4 v[36:39], v8, s[52:55], s15 offen offset:1024 sc1
    buffer_load_dwordx4 v[40:43], v8, s[52:55], s15 offen offset:2048 sc1
L_noqp56:
    s_waitcnt lgkmcnt(8)
    v_mfma_f32_32x32x16_bf16 v[48:63], v[204:207], v[164:167], v[48:63]
    ds_read_b64_tr_b16 v[200:201], v7 offset:61440
    ds_read_b64_tr_b16 v[202:203], v7 offset:61952
    s_waitcnt lgkmcnt(8)
    v_mfma_f32_32x32x16_bf16 v[48:63], v[208:211], v[168:171], v[48:63]
    ds_read_b64_tr_b16 v[204:205], v7 offset:63488
    ds_read_b64_tr_b16 v[206:207], v7 offset:64000
    s_waitcnt lgkmcnt(8)
    v_mfma_f32_32x32x16_bf16 v[48:63], v[212:215], v[172:175], v[48:63]
    s_waitcnt lgkmcnt(6)
    v_mfma_f32_32x32x16_bf16 v[48:63], v[192:195], v[176:179], v[48:63]
    s_waitcnt lgkmcnt(4)
    v_mfma_f32_32x32x16_bf16 v[48:63], v[196:199], v[180:183], v[48:63]
    s_waitcnt lgkmcnt(2)
    v_mfma_f32_32x32x16_bf16 v[48:63], v[200:203], v[184:187], v[48:63]
    s_waitcnt lgkmcnt(0)
    v_mfma_f32_32x32x16_bf16 v[48:63], v[204:207], v[188:191], v[48:63]
    s_setprio 0
    s_lshl_b32 s24, s43, 10
    v_add_u32 v15, s24, v249
    s_cmp_eq_u32 s38, 1
    s_cbranch_scc1 L_qa
    s_nop 6
    v_mul_f32 v48, s27, v48
    v_mul_f32 v49, s27, v49
    v_mul_f32 v50, s27, v50
    v_mul_f32 v51, s27, v51
    v_mul_f32 v52, s27, v52
    v_mul_f32 v53, s27, v53
    v_mul_f32 v54, s27, v54
    v_mul_f32 v55, s27, v55
    v_mul_f32 v56, s27, v56
    v_mul_f32 v57, s27, v57
    v_mul_f32 v58, s27, v58
    v_mul_f32 v59, s27, v59
    v_mul_f32 v60, s27, v60
    v_mul_f32 v61, s27, v61
    v_mul_f32 v62, s27, v62
    v_mul_f32 v63, s27, v63
    v_cvt_pk_bf16_f32 v24, v48, v49
    v_cvt_pk_bf16_f32 v25, v50, v51
    v_cvt_pk_bf16_f32 v26, v52, v53
    v_cvt_pk_bf16_f32 v27, v54, v55
    v_cvt_pk_bf16_f32 v28, v56, v57
    v_cvt_pk_bf16_f32 v29, v58, v59
    v_cvt_pk_bf16_f32 v30, v60, v61
    v_cvt_pk_bf16_f32 v31, v62, v63
    ds_write_b128 v249, v[24:27]
    s_waitcnt lgkmcnt(0)
    s_barrier
    buffer_load_dwordx4 v[32:35], v8, s[52:55], s15 offen offset:0 sc1
    buffer_load_dwordx4 v[36:39], v8, s[52:55], s15 offen offset:1024 sc1
    buffer_load_dwordx4 v[40:43], v8, s[52:55], s15 offen offset:2048 sc1
    s_waitcnt vmcnt(0)
    v_cmp_ne_u32_e64 s[24:25], s60, v35
    v_cmp_ne_u32 vcc, s60, v39
    s_or_b64 s[24:25], s[24:25], vcc
    v_cmp_ne_u32 vcc, s60, v43
    s_or_b64 s[24:25], s[24:25], vcc
    s_cbranch_scc1 L_gs3
L_gd3:
    v_mov_b32 v104, v32
    v_mov_b32 v105, v33
    v_mov_b32 v106, v34
    v_mov_b32 v107, v36
    v_mov_b32 v108, v37
    v_mov_b32 v109, v38
    v_mov_b32 v110, v40
    v_mov_b32 v111, v41
    s_setprio 1
    s_branch L_qb
L_wo:
    s_setprio 0
    s_xor_b32 m0, s5, 0
    s_lshl_b32 s24, m0, 3
    buffer_load_dwordx4 v247, s[44:47], s24 offen lds
    s_xor_b32 m0, s5, 4096
    s_lshl_b32 s24, m0, 3
    buffer_load_dwordx4 v247, s[44:47], s24 offen lds
    s_xor_b32 m0, s5, 8192
    s_lshl_b32 s24, m0, 3
    buffer_load_dwordx4 v247, s[44:47], s24 offen lds
    s_xor_b32 m0, s5, 12288
    s_lshl_b32 s24, m0, 3
    buffer_load_dwordx4 v247, s[44:47], s24 offen lds
    s_xor_b32 m0, s5, 16384
    s_lshl_b32 s24, m0, 3
    buffer_load_dwordx4 v247, s[44:47], s24 offen lds
    s_xor_b32 m0, s5, 20480
    s_lshl_b32 s24, m0, 3
    buffer_load_dwordx4 v247, s[44:47], s24 offen lds
    s_xor_b32 m0, s5, 24576
    s_lshl_b32 s24, m0, 3
    buffer_load_dwordx4 v247, s[44:47], s24 offen lds
    s_xor_b32 m0, s5, 28672
    s_lshl_b32 s24, m0, 3
    buffer_load_dwordx4 v247, s[44:47], s24 offen lds
    s_xor_b32 m0, s5, 32768
    s_lshl_b32 s24, m0, 3
    buffer_load_dwordx4 v247, s[44:47], s24 offen lds
    s_xor_b32 m0, s5, 36864
    s_lshl_b32 s24, m0, 3
    buffer_load_dwordx4 v247, s[44:47], s24 offen lds
    s_xor_b32 m0, s5, 40960
    s_lshl_b32 s24, m0, 3
    buffer_load_dwordx4 v247, s[44:47], s24 offen lds
    s_xor_b32 m0, s5, 45056
    s_lshl_b32 s24, m0, 3
    buffer_load_dwordx4 v247, s[44:47], s24 offen lds
    s_xor_b32 m0, s5, 49152
    s_lshl_b32 s24, m0, 3
    buffer_load_dwordx4 v247, s[44:47], s24 offen lds
    s_xor_b32 m0, s5, 53248
    s_lshl_b32 s24, m0, 3
    buffer_load_dwordx4 v247, s[44:47], s24 offen lds
    s_xor_b32 m0, s5, 57344
    s_lshl_b32 s24, m0, 3
    buffer_load_dwordx4 v247, s[44:47], s24 offen lds
    s_xor_b32 m0, s5, 61440
    s_lshl_b32 s24, m0, 3
    buffer_load_dwordx4 v247, s[44:47], s24 offen lds
    s_branch L_att
L_qa:
    s_nop 8
    v_cvt_pk_bf16_f32 v104, v48, v49
    v_cvt_pk_bf16_f32 v105, v50, v51
    v_cvt_pk_bf16_f32 v106, v52, v53
    v_cvt_pk_bf16_f32 v107, v54, v55
    v_cvt_pk_bf16_f32 v108, v56, v57
    v_cvt_pk_bf16_f32 v109, v58, v59
    v_cvt_pk_bf16_f32 v110, v60, v61
    v_cvt_pk_bf16_f32 v111, v62, v63
L_qb:
    s_nop 1
    v_mfma_f32_32x32x16_bf16 v[64:79], v[16:19], v[104:107], 0
    v_mfma_f32_32x32x16_bf16 v[80:95], v[20:23], v[108:111], 0
    s_nop 10
    v_max3_f32 v96, v64, v65, v66
    v_max3_f32 v98, v80, v81, v82
    v_max3_f32 v97, -v64, -v65, -v66
    v_max3_f32 v99, -v80, -v81, -v82
    v_max3_f32 v96, v96, v67, v68
    v_max3_f32 v98, v98, v83, v84
    v_max3_f32 v97, v97, -v67, -v68
    v_max3_f32 v99, v99, -v83, -v84
    v_max3_f32 v96, v96, v69, v70
    v_max3_f32 v98, v98, v85, v86
    v_max3_f32 v97, v97, -v69, -v70
    v_max3_f32 v99, v99, -v85, -v86
    v_max_f32_e64 v96, v96, v71
    v_max_f32_e64 v98, v98, v87
    v_max_f32_e64 v97, v97, -v71
    v_max_f32_e64 v99, v99, -v87
    s_nop 0
    v_permlane32_swap_b32 v96, v97
    v_permlane32_swap_b32 v98, v99
    v_max_f32 v96, v96, v97
    v_max_f32 v98, v98, v99
    v_mul_f32 v96, s62, v96
    v_mul_f32 v98, s62, v98
    v_mov_b32 v97, v96
    v_mov_b32 v99, v98
    s_nop 0
    v_permlane32_swap_b32 v96, v97
    v_permlane32_swap_b32 v98, v99
    v_fma_f32 v72, -v64, s62, -v97
    v_fma_f32 v88, -v80, s62, -v99
    v_fma_f32 v64, v64, s62, -v96
    v_fma_f32 v80, v80, s62, -v98
    v_fma_f32 v73, -v65, s62, -v97
    v_fma_f32 v89, -v81, s62, -v99
    v_fma_f32 v65, v65, s62, -v96
    v_fma_f32 v81, v81, s62, -v98
    v_fma_f32 v74, -v66, s62, -v97
    v_fma_f32 v90, -v82, s62, -v99
    v_fma_f32 v66, v66, s62, -v96
    v_fma_f32 v82, v82, s62, -v98
    v_fma_f32 v75, -v67, s62, -v97
    v_fma_f32 v91, -v83, s62, -v99
    v_fma_f32 v67, v67, s62, -v96
    v_fma_f32 v83, v83, s62, -v98
    v_fma_f32 v76, -v68, s62, -v97
    v_fma_f32 v92, -v84, s62, -v99
    v_fma_f32 v68, v68, s62, -v96
    v_fma_f32 v84, v84, s62, -v98
    v_fma_f32 v77, -v69, s62, -v97
    v_fma_f32 v93, -v85, s62, -v99
    v_fma_f32 v69, v69, s62, -v96
    v_fma_f32 v85, v85, s62, -v98
    v_fma_f32 v78, -v70, s62, -v97
    v_fma_f32 v94, -v86, s62, -v99
    v_fma_f32 v70, v70, s62, -v96
    v_fma_f32 v86, v86, s62, -v98
    v_fma_f32 v79, -v71, s62, -v97
    v_fma_f32 v95, -v87, s62, -v99
    v_fma_f32 v71, v71, s62, -v96
    v_fma_f32 v87, v87, s62, -v98
    v_exp_f32 v72, v72
    v_exp_f32 v88, v88
    v_exp_f32 v64, v64
    v_exp_f32 v80, v80
    v_exp_f32 v73, v73
    v_exp_f32 v89, v89
    v_exp_f32 v65, v65
    v_exp_f32 v81, v81
    v_exp_f32 v74, v74
    v_exp_f32 v90, v90
    v_exp_f32 v66, v66
    v_exp_f32 v82, v82
    v_exp_f32 v75, v75
    v_exp_f32 v91, v91
    v_exp_f32 v67, v67
    v_exp_f32 v83, v83
    v_exp_f32 v76, v76
    v_exp_f32 v92, v92
    v_exp_f32 v68, v68
    v_exp_f32 v84, v84
    v_exp_f32 v77, v77
    v_exp_f32 v93, v93
    v_exp_f32 v69, v69
    v_exp_f32 v85, v85
    v_exp_f32 v78, v78
    v_exp_f32 v94, v94
    v_exp_f32 v70, v70
    v_exp_f32 v86, v86
    v_exp_f32 v79, v79
    v_exp_f32 v95, v95
    v_exp_f32 v71, v71
    v_exp_f32 v87, v87
    v_cvt_pk_bf16_f32 v104, v64, v65
    v_cvt_pk_bf16_f32 v48, v80, v81
    v_cvt_pk_bf16_f32 v105, v66, v67
    v_cvt_pk_bf16_f32 v49, v82, v83
    v_cvt_pk_bf16_f32 v106, v68, v69
    v_cvt_pk_bf16_f32 v50, v84, v85
    v_cvt_pk_bf16_f32 v107, v70, v71
    v_cvt_pk_bf16_f32 v51, v86, v87
    v_cvt_pk_bf16_f32 v108, v72, v73
    v_cvt_pk_bf16_f32 v52, v88, v89
    v_cvt_pk_bf16_f32 v109, v74, v75
    v_cvt_pk_bf16_f32 v53, v90, v91
    v_cvt_pk_bf16_f32 v110, v76, v77
    v_cvt_pk_bf16_f32 v54, v92, v93
    v_cvt_pk_bf16_f32 v111, v78, v79
    v_cvt_pk_bf16_f32 v55, v94, v95
    ds_write_b128 v15, v[104:107] offset:4096
    ds_write_b128 v15, v[108:111] offset:5120
    v_mov_b32 v14, 149376
    s_mov_b64 exec, 1
    ds_add_u32 v14, v243 offset:16
    s_mov_b64 exec, -1
    s_cmp_eq_u32 s38, 0
    s_cbranch_scc1 L_wo
    s_mov_b32 s3, 0
L_gl4:
    s_waitcnt vmcnt(0)
    v_cmp_ne_u32_e64 s[24:25], s60, v35
    v_cmp_ne_u32 vcc, s60, v39
    s_or_b64 s[24:25], s[24:25], vcc
    v_cmp_ne_u32 vcc, s60, v43
    s_or_b64 s[24:25], s[24:25], vcc
    s_cbranch_scc0 L_gd4
    s_sleep 2
    buffer_load_dwordx4 v[32:35], v8, s[52:55], s15 offen offset:0 sc1
    buffer_load_dwordx4 v[36:39], v8, s[52:55], s15 offen offset:1024 sc1
    buffer_load_dwordx4 v[40:43], v8, s[52:55], s15 offen offset:2048 sc1
    s_add_u32 s3, s3, 1
    s_cmp_lt_u32 s3, 65536
    s_cbranch_scc1 L_gl4
    s_waitcnt vmcnt(0)
L_gd4:
    v_mov_b32 v24, v32
    v_mov_b32 v25, v33
    v_mov_b32 v26, v34
    v_mov_b32 v27, v36
    v_mov_b32 v28, v37
    v_mov_b32 v29, v38
    v_mov_b32 v30, v40
    v_mov_b32 v31, v41
    ds_write_b128 v249, v[24:27]
    s_waitcnt lgkmcnt(0)
    s_barrier
    s_branch L_wo
L_cons:
L_chain2:
L_pad2:
    s_cbranch_execz L_padret0
    s_waitcnt lgkmcnt(0)
    s_barrier
    ds_read_b128 v[16:19], v2 offset:0
    ds_read_b64_tr_b16 v[32:33], v4 offset:16384
    ds_read_b64_tr_b16 v[34:35], v4 offset:16896
    ds_read_b128 v[20:23], v2 offset:2048
    ds_read_b64_tr_b16 v[36:37], v5 offset:16384
    ds_read_b64_tr_b16 v[38:39], v5 offset:16896
    ds_read_b128 v[24:27], v2 offset:4096
    ds_read_b128 v[28:31], v2 offset:6144
    ds_read_b64_tr_b16 v[40:41], v6 offset:24576
    ds_read_b64_tr_b16 v[42:43], v6 offset:25088
    ds_read_b64_tr_b16 v[44:45], v7 offset:24576
    ds_read_b64_tr_b16 v[46:47], v7 offset:25088
    s_waitcnt lgkmcnt(9)
    v_mfma_f32_16x16x32_bf16 v[96:99], v[32:35], v[16:19], 0
    s_cmp_lt_u32 s2, 32
    s_cbranch_scc1 L_d4
L_d5:
    ds_read_b128 v[64:67], v3 offset:0
    ds_read_b64_tr_b16 v[80:81], v4 offset:20480
    s_waitcnt lgkmcnt(8)
    v_mfma_f32_16x16x32_bf16 v[104:107], v[36:39], v[16:19], 0
    ds_read_b64_tr_b16 v[82:83], v4 offset:20992
    ds_read_b128 v[68:71], v3 offset:2048
    v_mfma_f32_16x16x32_bf16 v[100:103], v[32:35], v[20:23], 0
    ds_read_b64_tr_b16 v[84:85], v5 offset:20480
    ds_read_b64_tr_b16 v[86:87], v5 offset:20992
    v_mfma_f32_16x16x32_bf16 v[108:111], v[36:39], v[20:23], 0
    ds_read_b128 v[72:75], v3 offset:4096
    ds_read_b128 v[76:79], v3 offset:6144
    s_waitcnt lgkmcnt(12)
    v_mfma_f32_16x16x32_bf16 v[112:115], v[32:35], v[24:27], 0
    ds_read_b64_tr_b16 v[88:89], v6 offset:28672
    ds_read_b64_tr_b16 v[90:91], v6 offset:29184
    v_mfma_f32_16x16x32_bf16 v[120:123], v[36:39], v[24:27], 0
    ds_read_b64_tr_b16 v[92:93], v7 offset:28672
    ds_read_b64_tr_b16 v[94:95], v7 offset:29184
    v_mfma_f32_16x16x32_bf16 v[116:119], v[32:35], v[28:31], 0
    v_mfma_f32_16x16x32_bf16 v[124:127], v[36:39], v[28:31], 0
    s_waitcnt lgkmcnt(12)
    v_mfma_f32_16x16x32_bf16 v[128:131], v[16:19], v[40:43], 0
    v_mfma_f32_16x16x32_bf16 v[132:135], v[16:19], v[44:47], 0
    v_mfma_f32_16x16x32_bf16 v[136:139], v[20:23], v[40:43], 0
    v_mfma_f32_16x16x32_bf16 v[140:143], v[20:23], v[44:47], 0
    v_mfma_f32_16x16x32_bf16 v[144:147], v[24:27], v[40:43], 0
    v_mfma_f32_16x16x32_bf16 v[148:151], v[24:27], v[44:47], 0
    v_mfma_f32_16x16x32_bf16 v[152:155], v[28:31], v[40:43], 0
    v_mfma_f32_16x16x32_bf16 v[156:159], v[28:31], v[44:47], 0
    s_waitcnt lgkmcnt(4)
    v_mfma_f32_16x16x32_bf16 v[96:99], v[80:83], v[64:67], v[96:99]
    v_mfma_f32_16x16x32_bf16 v[104:107], v[84:87], v[64:67], v[104:107]
    s_waitcnt lgkmcnt(0)
    v_mfma_f32_16x16x32_bf16 v[100:103], v[80:83], v[68:71], v[100:103]
    s_barrier
    ds_read_b128 v[16:19], v2 offset:32768
    v_mfma_f32_16x16x32_bf16 v[108:111], v[84:87], v[68:71], v[108:111]
    ds_read_b64_tr_b16 v[32:33], v4 offset:49152
    v_mfma_f32_16x16x32_bf16 v[112:115], v[80:83], v[72:75], v[112:115]
    ds_read_b64_tr_b16 v[34:35], v4 offset:49664
    v_mfma_f32_16x16x32_bf16 v[120:123], v[84:87], v[72:75], v[120:123]
    ds_read_b128 v[20:23], v2 offset:34816
    v_mfma_f32_16x16x32_bf16 v[116:119], v[80:83], v[76:79], v[116:119]
    ds_read_b64_tr_b16 v[36:37], v5 offset:49152
    v_mfma_f32_16x16x32_bf16 v[124:127], v[84:87], v[76:79], v[124:127]
    ds_read_b64_tr_b16 v[38:39], v5 offset:49664
    v_mfma_f32_16x16x32_bf16 v[128:131], v[64:67], v[88:91], v[128:131]
    ds_read_b128 v[24:27], v2 offset:36864
    v_mfma_f32_16x16x32_bf16 v[132:135], v[64:67], v[92:95], v[132:135]
    ds_read_b128 v[28:31], v2 offset:38912
    v_mfma_f32_16x16x32_bf16 v[136:139], v[68:71], v[88:91], v[136:139]
    ds_read_b64_tr_b16 v[40:41], v6 offset:57344
    v_mfma_f32_16x16x32_bf16 v[140:143], v[68:71], v[92:95], v[140:143]
    ds_read_b64_tr_b16 v[42:43], v6 offset:57856
    v_mfma_f32_16x16x32_bf16 v[144:147], v[72:75], v[88:91], v[144:147]
    ds_read_b64_tr_b16 v[44:45], v7 offset:57344
    v_mfma_f32_16x16x32_bf16 v[148:151], v[72:75], v[92:95], v[148:151]
    ds_read_b64_tr_b16 v[46:47], v7 offset:57856
    v_mfma_f32_16x16x32_bf16 v[152:155], v[76:79], v[88:91], v[152:155]
    v_mfma_f32_16x16x32_bf16 v[156:159], v[76:79], v[92:95], v[156:159]
    s_waitcnt lgkmcnt(4)
    v_mfma_f32_16x16x32_bf16 v[96:99], v[32:35], v[16:19], v[96:99]
    ds_read_b128 v[64:67], v3 offset:32768
    ds_read_b64_tr_b16 v[80:81], v4 offset:53248
    v_mfma_f32_16x16x32_bf16 v[104:107], v[36:39], v[16:19], v[104:107]
    ds_read_b64_tr_b16 v[82:83], v4 offset:53760
    ds_read_b128 v[68:71], v3 offset:34816
    v_mfma_f32_16x16x32_bf16 v[100:103], v[32:35], v[20:23], v[100:103]
    ds_read_b64_tr_b16 v[84:85], v5 offset:53248
    ds_read_b64_tr_b16 v[86:87], v5 offset:53760
    v_mfma_f32_16x16x32_bf16 v[108:111], v[36:39], v[20:23], v[108:111]
    ds_read_b128 v[72:75], v3 offset:36864
    ds_read_b128 v[76:79], v3 offset:38912
    v_mfma_f32_16x16x32_bf16 v[112:115], v[32:35], v[24:27], v[112:115]
    ds_read_b64_tr_b16 v[88:89], v6 offset:61440
    ds_read_b64_tr_b16 v[90:91], v6 offset:61952
    v_mfma_f32_16x16x32_bf16 v[120:123], v[36:39], v[24:27], v[120:123]
    ds_read_b64_tr_b16 v[92:93], v7 offset:61440
    ds_read_b64_tr_b16 v[94:95], v7 offset:61952
    v_mfma_f32_16x16x32_bf16 v[116:119], v[32:35], v[28:31], v[116:119]
    v_mfma_f32_16x16x32_bf16 v[124:127], v[36:39], v[28:31], v[124:127]
    s_waitcnt lgkmcnt(12)
    v_mfma_f32_16x16x32_bf16 v[128:131], v[16:19], v[40:43], v[128:131]
    v_mfma_f32_16x16x32_bf16 v[132:135], v[16:19], v[44:47], v[132:135]
    v_mfma_f32_16x16x32_bf16 v[136:139], v[20:23], v[40:43], v[136:139]
    v_mfma_f32_16x16x32_bf16 v[140:143], v[20:23], v[44:47], v[140:143]
    v_mfma_f32_16x16x32_bf16 v[144:147], v[24:27], v[40:43], v[144:147]
    v_mfma_f32_16x16x32_bf16 v[148:151], v[24:27], v[44:47], v[148:151]
    v_mfma_f32_16x16x32_bf16 v[152:155], v[28:31], v[40:43], v[152:155]
    v_mfma_f32_16x16x32_bf16 v[156:159], v[28:31], v[44:47], v[156:159]
    s_waitcnt lgkmcnt(4)
    v_mfma_f32_16x16x32_bf16 v[96:99], v[80:83], v[64:67], v[96:99]
    v_mfma_f32_16x16x32_bf16 v[104:107], v[84:87], v[64:67], v[104:107]
    s_waitcnt lgkmcnt(0)
    v_mfma_f32_16x16x32_bf16 v[100:103], v[80:83], v[68:71], v[100:103]
    s_barrier
    ds_read_b128 v[16:19], v160 offset:0
    v_mfma_f32_16x16x32_bf16 v[108:111], v[84:87], v[68:71], v[108:111]
    ds_read_b64_tr_b16 v[32:33], v162 offset:16384
    v_mfma_f32_16x16x32_bf16 v[112:115], v[80:83], v[72:75], v[112:115]
    ds_read_b64_tr_b16 v[34:35], v162 offset:16896
    v_mfma_f32_16x16x32_bf16 v[120:123], v[84:87], v[72:75], v[120:123]
    ds_read_b128 v[20:23], v160 offset:2048
    v_mfma_f32_16x16x32_bf16 v[116:119], v[80:83], v[76:79], v[116:119]
    ds_read_b64_tr_b16 v[36:37], v163 offset:16384
    v_mfma_f32_16x16x32_bf16 v[124:127], v[84:87], v[76:79], v[124:127]
    ds_read_b64_tr_b16 v[38:39], v163 offset:16896
    v_mfma_f32_16x16x32_bf16 v[128:131], v[64:67], v[88:91], v[128:131]
    ds_read_b128 v[24:27], v160 offset:4096
    v_mfma_f32_16x16x32_bf16 v[132:135], v[64:67], v[92:95], v[132:135]
    ds_read_b128 v[28:31], v160 offset:6144
    v_mfma_f32_16x16x32_bf16 v[136:139], v[68:71], v[88:91], v[136:139]
    ds_read_b64_tr_b16 v[40:41], v164 offset:24576
    v_mfma_f32_16x16x32_bf16 v[140:143], v[68:71], v[92:95], v[140:143]
    ds_read_b64_tr_b16 v[42:43], v164 offset:25088
    v_mfma_f32_16x16x32_bf16 v[144:147], v[72:75], v[88:91], v[144:147]
    ds_read_b64_tr_b16 v[44:45], v165 offset:24576
    v_mfma_f32_16x16x32_bf16 v[148:151], v[72:75], v[92:95], v[148:151]
    ds_read_b64_tr_b16 v[46:47], v165 offset:25088
    v_mfma_f32_16x16x32_bf16 v[152:155], v[76:79], v[88:91], v[152:155]
    v_mfma_f32_16x16x32_bf16 v[156:159], v[76:79], v[92:95], v[156:159]
    s_waitcnt lgkmcnt(4)
    v_mfma_f32_16x16x32_bf16 v[96:99], v[32:35], v[16:19], v[96:99]
    ds_read_b128 v[64:67], v161 offset:0
    ds_read_b64_tr_b16 v[80:81], v162 offset:20480
    v_mfma_f32_16x16x32_bf16 v[104:107], v[36:39], v[16:19], v[104:107]
    ds_read_b64_tr_b16 v[82:83], v162 offset:20992
    ds_read_b128 v[68:71], v161 offset:2048
    v_mfma_f32_16x16x32_bf16 v[100:103], v[32:35], v[20:23], v[100:103]
    ds_read_b64_tr_b16 v[84:85], v163 offset:20480
    ds_read_b64_tr_b16 v[86:87], v163 offset:20992
    v_mfma_f32_16x16x32_bf16 v[108:111], v[36:39], v[20:23], v[108:111]
    ds_read_b128 v[72:75], v161 offset:4096
    ds_read_b128 v[76:79], v161 offset:6144
    v_mfma_f32_16x16x32_bf16 v[112:115], v[32:35], v[24:27], v[112:115]
    ds_read_b64_tr_b16 v[88:89], v164 offset:28672
    ds_read_b64_tr_b16 v[90:91], v164 offset:29184
    v_mfma_f32_16x16x32_bf16 v[120:123], v[36:39], v[24:27], v[120:123]
    ds_read_b64_tr_b16 v[92:93], v165 offset:28672
    ds_read_b64_tr_b16 v[94:95], v165 offset:29184
    v_mfma_f32_16x16x32_bf16 v[116:119], v[32:35], v[28:31], v[116:119]
    v_mfma_f32_16x16x32_bf16 v[124:127], v[36:39], v[28:31], v[124:127]
    s_waitcnt lgkmcnt(12)
    v_mfma_f32_16x16x32_bf16 v[128:131], v[16:19], v[40:43], v[128:131]
    v_mfma_f32_16x16x32_bf16 v[132:135], v[16:19], v[44:47], v[132:135]
    v_mfma_f32_16x16x32_bf16 v[136:139], v[20:23], v[40:43], v[136:139]
    v_mfma_f32_16x16x32_bf16 v[140:143], v[20:23], v[44:47], v[140:143]
    v_mfma_f32_16x16x32_bf16 v[144:147], v[24:27], v[40:43], v[144:147]
    v_mfma_f32_16x16x32_bf16 v[148:151], v[24:27], v[44:47], v[148:151]
    v_mfma_f32_16x16x32_bf16 v[152:155], v[28:31], v[40:43], v[152:155]
    v_mfma_f32_16x16x32_bf16 v[156:159], v[28:31], v[44:47], v[156:159]
L_chain3:
L_pad3:
    s_cbranch_execz L_padret0
    s_waitcnt lgkmcnt(4)
    v_mfma_f32_16x16x32_bf16 v[96:99], v[80:83], v[64:67], v[96:99]
    v_mfma_f32_16x16x32_bf16 v[104:107], v[84:87], v[64:67], v[104:107]
    s_waitcnt lgkmcnt(0)
    v_mfma_f32_16x16x32_bf16 v[100:103], v[80:83], v[68:71], v[100:103]
    s_barrier
    ds_read_b128 v[16:19], v160 offset:32768
    v_mfma_f32_16x16x32_bf16 v[108:111], v[84:87], v[68:71], v[108:111]
    ds_read_b64_tr_b16 v[32:33], v162 offset:49152
    v_mfma_f32_16x16x32_bf16 v[112:115], v[80:83], v[72:75], v[112:115]
    ds_read_b64_tr_b16 v[34:35], v162 offset:49664
    v_mfma_f32_16x16x32_bf16 v[120:123], v[84:87], v[72:75], v[120:123]
    ds_read_b128 v[20:23], v160 offset:34816
    v_mfma_f32_16x16x32_bf16 v[116:119], v[80:83], v[76:79], v[116:119]
    ds_read_b64_tr_b16 v[36:37], v163 offset:49152
    v_mfma_f32_16x16x32_bf16 v[124:127], v[84:87], v[76:79], v[124:127]
    ds_read_b64_tr_b16 v[38:39], v163 offset:49664
    v_mfma_f32_16x16x32_bf16 v[128:131], v[64:67], v[88:91], v[128:131]
    ds_read_b128 v[24:27], v160 offset:36864
    v_mfma_f32_16x16x32_bf16 v[132:135], v[64:67], v[92:95], v[132:135]
    ds_read_b128 v[28:31], v160 offset:38912
    v_mfma_f32_16x16x32_bf16 v[136:139], v[68:71], v[88:91], v[136:139]
    ds_read_b64_tr_b16 v[40:41], v164 offset:57344
    v_mfma_f32_16x16x32_bf16 v[140:143], v[68:71], v[92:95], v[140:143]
    ds_read_b64_tr_b16 v[42:43], v164 offset:57856
    v_mfma_f32_16x16x32_bf16 v[144:147], v[72:75], v[88:91], v[144:147]
    ds_read_b64_tr_b16 v[44:45], v165 offset:57344
    v_mfma_f32_16x16x32_bf16 v[148:151], v[72:75], v[92:95], v[148:151]
    ds_read_b64_tr_b16 v[46:47], v165 offset:57856
    v_mfma_f32_16x16x32_bf16 v[152:155], v[76:79], v[88:91], v[152:155]
    v_mfma_f32_16x16x32_bf16 v[156:159], v[76:79], v[92:95], v[156:159]
    s_waitcnt lgkmcnt(4)
    v_mfma_f32_16x16x32_bf16 v[96:99], v[32:35], v[16:19], v[96:99]
    ds_read_b128 v[64:67], v161 offset:32768
    ds_read_b64_tr_b16 v[80:81], v162 offset:53248
    v_mfma_f32_16x16x32_bf16 v[104:107], v[36:39], v[16:19], v[104:107]
    ds_read_b64_tr_b16 v[82:83], v162 offset:53760
    ds_read_b128 v[68:71], v161 offset:34816
    v_mfma_f32_16x16x32_bf16 v[100:103], v[32:35], v[20:23], v[100:103]
    ds_read_b64_tr_b16 v[84:85], v163 offset:53248
    ds_read_b64_tr_b16 v[86:87], v163 offset:53760
    v_mfma_f32_16x16x32_bf16 v[108:111], v[36:39], v[20:23], v[108:111]
    ds_read_b128 v[72:75], v161 offset:36864
    ds_read_b128 v[76:79], v161 offset:38912
    v_mfma_f32_16x16x32_bf16 v[112:115], v[32:35], v[24:27], v[112:115]
    ds_read_b64_tr_b16 v[88:89], v164 offset:61440
    ds_read_b64_tr_b16 v[90:91], v164 offset:61952
    v_mfma_f32_16x16x32_bf16 v[120:123], v[36:39], v[24:27], v[120:123]
    ds_read_b64_tr_b16 v[92:93], v165 offset:61440
    ds_read_b64_tr_b16 v[94:95], v165 offset:61952
    v_mfma_f32_16x16x32_bf16 v[116:119], v[32:35], v[28:31], v[116:119]
    v_mfma_f32_16x16x32_bf16 v[124:127], v[36:39], v[28:31], v[124:127]
    s_waitcnt lgkmcnt(12)
    v_mfma_f32_16x16x32_bf16 v[128:131], v[16:19], v[40:43], v[128:131]
    v_mfma_f32_16x16x32_bf16 v[132:135], v[16:19], v[44:47], v[132:135]
    v_mfma_f32_16x16x32_bf16 v[136:139], v[20:23], v[40:43], v[136:139]
    v_mfma_f32_16x16x32_bf16 v[140:143], v[20:23], v[44:47], v[140:143]
    v_mfma_f32_16x16x32_bf16 v[144:147], v[24:27], v[40:43], v[144:147]
    v_mfma_f32_16x16x32_bf16 v[148:151], v[24:27], v[44:47], v[148:151]
    v_mfma_f32_16x16x32_bf16 v[152:155], v[28:31], v[40:43], v[152:155]
    v_mfma_f32_16x16x32_bf16 v[156:159], v[28:31], v[44:47], v[156:159]
    s_waitcnt lgkmcnt(4)
    v_mfma_f32_16x16x32_bf16 v[96:99], v[80:83], v[64:67], v[96:99]
    v_mfma_f32_16x16x32_bf16 v[104:107], v[84:87], v[64:67], v[104:107]
    s_waitcnt lgkmcnt(0)
    v_mfma_f32_16x16x32_bf16 v[100:103], v[80:83], v[68:71], v[100:103]
    s_barrier
    ds_read_b128 v[16:19], v2 offset:0
    v_mfma_f32_16x16x32_bf16 v[108:111], v[84:87], v[68:71], v[108:111]
    ds_read_b64_tr_b16 v[32:33], v4 offset:16384
    v_mfma_f32_16x16x32_bf16 v[112:115], v[80:83], v[72:75], v[112:115]
    ds_read_b64_tr_b16 v[34:35], v4 offset:16896
    v_mfma_f32_16x16x32_bf16 v[120:123], v[84:87], v[72:75], v[120:123]
    ds_read_b128 v[20:23], v2 offset:2048
    v_mfma_f32_16x16x32_bf16 v[116:119], v[80:83], v[76:79], v[116:119]
    ds_read_b64_tr_b16 v[36:37], v5 offset:16384
    v_mfma_f32_16x16x32_bf16 v[124:127], v[84:87], v[76:79], v[124:127]
    ds_read_b64_tr_b16 v[38:39], v5 offset:16896
    v_mfma_f32_16x16x32_bf16 v[128:131], v[64:67], v[88:91], v[128:131]
    ds_read_b128 v[24:27], v2 offset:4096
    v_mfma_f32_16x16x32_bf16 v[132:135], v[64:67], v[92:95], v[132:135]
    ds_read_b128 v[28:31], v2 offset:6144
    v_mfma_f32_16x16x32_bf16 v[136:139], v[68:71], v[88:91], v[136:139]
    ds_read_b64_tr_b16 v[40:41], v6 offset:24576
    v_mfma_f32_16x16x32_bf16 v[140:143], v[68:71], v[92:95], v[140:143]
    ds_read_b64_tr_b16 v[42:43], v6 offset:25088
    v_mfma_f32_16x16x32_bf16 v[144:147], v[72:75], v[88:91], v[144:147]
    ds_read_b64_tr_b16 v[44:45], v7 offset:24576
    v_mfma_f32_16x16x32_bf16 v[148:151], v[72:75], v[92:95], v[148:151]
    ds_read_b64_tr_b16 v[46:47], v7 offset:25088
    v_mfma_f32_16x16x32_bf16 v[152:155], v[76:79], v[88:91], v[152:155]
    v_mfma_f32_16x16x32_bf16 v[156:159], v[76:79], v[92:95], v[156:159]
    s_waitcnt lgkmcnt(4)
    v_mfma_f32_16x16x32_bf16 v[96:99], v[32:35], v[16:19], v[96:99]
    ds_read_b128 v[64:67], v3 offset:0
    ds_read_b64_tr_b16 v[80:81], v4 offset:20480
    v_mfma_f32_16x16x32_bf16 v[104:107], v[36:39], v[16:19], v[104:107]
    ds_read_b64_tr_b16 v[82:83], v4 offset:20992
    ds_read_b128 v[68:71], v3 offset:2048
    v_mfma_f32_16x16x32_bf16 v[100:103], v[32:35], v[20:23], v[100:103]
    ds_read_b64_tr_b16 v[84:85], v5 offset:20480
    ds_read_b64_tr_b16 v[86:87], v5 offset:20992
    v_mfma_f32_16x16x32_bf16 v[108:111], v[36:39], v[20:23], v[108:111]
    ds_read_b128 v[72:75], v3 offset:4096
    ds_read_b128 v[76:79], v3 offset:6144
    v_mfma_f32_16x16x32_bf16 v[112:115], v[32:35], v[24:27], v[112:115]
    ds_read_b64_tr_b16 v[88:89], v6 offset:28672
    ds_read_b64_tr_b16 v[90:91], v6 offset:29184
    v_mfma_f32_16x16x32_bf16 v[120:123], v[36:39], v[24:27], v[120:123]
    ds_read_b64_tr_b16 v[92:93], v7 offset:28672
    ds_read_b64_tr_b16 v[94:95], v7 offset:29184
    v_mfma_f32_16x16x32_bf16 v[116:119], v[32:35], v[28:31], v[116:119]
    v_mfma_f32_16x16x32_bf16 v[124:127], v[36:39], v[28:31], v[124:127]
    s_waitcnt lgkmcnt(12)
    v_mfma_f32_16x16x32_bf16 v[128:131], v[16:19], v[40:43], v[128:131]
    v_mfma_f32_16x16x32_bf16 v[132:135], v[16:19], v[44:47], v[132:135]
    v_mfma_f32_16x16x32_bf16 v[136:139], v[20:23], v[40:43], v[136:139]
    v_mfma_f32_16x16x32_bf16 v[140:143], v[20:23], v[44:47], v[140:143]
    v_mfma_f32_16x16x32_bf16 v[144:147], v[24:27], v[40:43], v[144:147]
    v_mfma_f32_16x16x32_bf16 v[148:151], v[24:27], v[44:47], v[148:151]
    v_mfma_f32_16x16x32_bf16 v[152:155], v[28:31], v[40:43], v[152:155]
    v_mfma_f32_16x16x32_bf16 v[156:159], v[28:31], v[44:47], v[156:159]
    s_waitcnt lgkmcnt(4)
    v_mfma_f32_16x16x32_bf16 v[96:99], v[80:83], v[64:67], v[96:99]
    v_mfma_f32_16x16x32_bf16 v[104:107], v[84:87], v[64:67], v[104:107]
    s_waitcnt lgkmcnt(0)
    v_mfma_f32_16x16x32_bf16 v[100:103], v[80:83], v[68:71], v[100:103]
    s_barrier
    ds_read_b128 v[16:19], v2 offset:32768
    v_mfma_f32_16x16x32_bf16 v[108:111], v[84:87], v[68:71], v[108:111]
    ds_read_b64_tr_b16 v[32:33], v4 offset:49152
    v_mfma_f32_16x16x32_bf16 v[112:115], v[80:83], v[72:75], v[112:115]
    ds_read_b64_tr_b16 v[34:35], v4 offset:49664
    v_mfma_f32_16x16x32_bf16 v[120:123], v[84:87], v[72:75], v[120:123]
    ds_read_b128 v[20:23], v2 offset:34816
    v_mfma_f32_16x16x32_bf16 v[116:119], v[80:83], v[76:79], v[116:119]
    ds_read_b64_tr_b16 v[36:37], v5 offset:49152
    v_mfma_f32_16x16x32_bf16 v[124:127], v[84:87], v[76:79], v[124:127]
    ds_read_b64_tr_b16 v[38:39], v5 offset:49664
    v_mfma_f32_16x16x32_bf16 v[128:131], v[64:67], v[88:91], v[128:131]
    ds_read_b128 v[24:27], v2 offset:36864
    v_mfma_f32_16x16x32_bf16 v[132:135], v[64:67], v[92:95], v[132:135]
    ds_read_b128 v[28:31], v2 offset:38912
    v_mfma_f32_16x16x32_bf16 v[136:139], v[68:71], v[88:91], v[136:139]
    ds_read_b64_tr_b16 v[40:41], v6 offset:57344
    v_mfma_f32_16x16x32_bf16 v[140:143], v[68:71], v[92:95], v[140:143]
    ds_read_b64_tr_b16 v[42:43], v6 offset:57856
    v_mfma_f32_16x16x32_bf16 v[144:147], v[72:75], v[88:91], v[144:147]
    ds_read_b64_tr_b16 v[44:45], v7 offset:57344
    v_mfma_f32_16x16x32_bf16 v[148:151], v[72:75], v[92:95], v[148:151]
    ds_read_b64_tr_b16 v[46:47], v7 offset:57856
    v_mfma_f32_16x16x32_bf16 v[152:155], v[76:79], v[88:91], v[152:155]
    v_mfma_f32_16x16x32_bf16 v[156:159], v[76:79], v[92:95], v[156:159]
    s_waitcnt lgkmcnt(4)
    v_mfma_f32_16x16x32_bf16 v[96:99], v[32:35], v[16:19], v[96:99]
    ds_read_b128 v[64:67], v3 offset:32768
    ds_read_b64_tr_b16 v[80:81], v4 offset:53248
    v_mfma_f32_16x16x32_bf16 v[104:107], v[36:39], v[16:19], v[104:107]
    ds_read_b64_tr_b16 v[82:83], v4 offset:53760
    ds_read_b128 v[68:71], v3 offset:34816
    v_mfma_f32_16x16x32_bf16 v[100:103], v[32:35], v[20:23], v[100:103]
    ds_read_b64_tr_b16 v[84:85], v5 offset:53248
    ds_read_b64_tr_b16 v[86:87], v5 offset:53760
    v_mfma_f32_16x16x32_bf16 v[108:111], v[36:39], v[20:23], v[108:111]
    ds_read_b128 v[72:75], v3 offset:36864
    ds_read_b128 v[76:79], v3 offset:38912
    v_mfma_f32_16x16x32_bf16 v[112:115], v[32:35], v[24:27], v[112:115]
    ds_read_b64_tr_b16 v[88:89], v6 offset:61440
    ds_read_b64_tr_b16 v[90:91], v6 offset:61952
    v_mfma_f32_16x16x32_bf16 v[120:123], v[36:39], v[24:27], v[120:123]
    ds_read_b64_tr_b16 v[92:93], v7 offset:61440
    ds_read_b64_tr_b16 v[94:95], v7 offset:61952
    v_mfma_f32_16x16x32_bf16 v[116:119], v[32:35], v[28:31], v[116:119]
    v_mfma_f32_16x16x32_bf16 v[124:127], v[36:39], v[28:31], v[124:127]
    s_waitcnt lgkmcnt(12)
    v_mfma_f32_16x16x32_bf16 v[128:131], v[16:19], v[40:43], v[128:131]
    v_mfma_f32_16x16x32_bf16 v[132:135], v[16:19], v[44:47], v[132:135]
    v_mfma_f32_16x16x32_bf16 v[136:139], v[20:23], v[40:43], v[136:139]
    v_mfma_f32_16x16x32_bf16 v[140:143], v[20:23], v[44:47], v[140:143]
    v_mfma_f32_16x16x32_bf16 v[144:147], v[24:27], v[40:43], v[144:147]
    v_mfma_f32_16x16x32_bf16 v[148:151], v[24:27], v[44:47], v[148:151]
    v_mfma_f32_16x16x32_bf16 v[152:155], v[28:31], v[40:43], v[152:155]
    v_mfma_f32_16x16x32_bf16 v[156:159], v[28:31], v[44:47], v[156:159]
    s_waitcnt vmcnt(0)
    s_waitcnt lgkmcnt(4)
    v_mfma_f32_16x16x32_bf16 v[96:99], v[80:83], v[64:67], v[96:99]
    v_mfma_f32_16x16x32_bf16 v[104:107], v[84:87], v[64:67], v[104:107]
    s_waitcnt lgkmcnt(0)
    v_mfma_f32_16x16x32_bf16 v[100:103], v[80:83], v[68:71], v[100:103]
    s_barrier
    ds_read_b128 v[16:19], v160 offset:0
    v_mfma_f32_16x16x32_bf16 v[108:111], v[84:87], v[68:71], v[108:111]
    ds_read_b64_tr_b16 v[32:33], v162 offset:16384
    v_mfma_f32_16x16x32_bf16 v[112:115], v[80:83], v[72:75], v[112:115]
    ds_read_b64_tr_b16 v[34:35], v162 offset:16896
    v_mfma_f32_16x16x32_bf16 v[120:123], v[84:87], v[72:75], v[120:123]
    ds_read_b128 v[20:23], v160 offset:2048
    v_mfma_f32_16x16x32_bf16 v[116:119], v[80:83], v[76:79], v[116:119]
    ds_read_b64_tr_b16 v[36:37], v163 offset:16384
    v_mfma_f32_16x16x32_bf16 v[124:127], v[84:87], v[76:79], v[124:127]
    ds_read_b64_tr_b16 v[38:39], v163 offset:16896
    v_mfma_f32_16x16x32_bf16 v[128:131], v[64:67], v[88:91], v[128:131]
    ds_read_b128 v[24:27], v160 offset:4096
    v_mfma_f32_16x16x32_bf16 v[132:135], v[64:67], v[92:95], v[132:135]
    ds_read_b128 v[28:31], v160 offset:6144
    v_mfma_f32_16x16x32_bf16 v[136:139], v[68:71], v[88:91], v[136:139]
    ds_read_b64_tr_b16 v[40:41], v164 offset:24576
    v_mfma_f32_16x16x32_bf16 v[140:143], v[68:71], v[92:95], v[140:143]
    ds_read_b64_tr_b16 v[42:43], v164 offset:25088
    v_mfma_f32_16x16x32_bf16 v[144:147], v[72:75], v[88:91], v[144:147]
    ds_read_b64_tr_b16 v[44:45], v165 offset:24576
    v_mfma_f32_16x16x32_bf16 v[148:151], v[72:75], v[92:95], v[148:151]
    ds_read_b64_tr_b16 v[46:47], v165 offset:25088
    v_mfma_f32_16x16x32_bf16 v[152:155], v[76:79], v[88:91], v[152:155]
    v_mfma_f32_16x16x32_bf16 v[156:159], v[76:79], v[92:95], v[156:159]
    ds_read_b64_tr_b16 v[56:57], v9 offset:0
    ds_read_b64_tr_b16 v[58:59], v9 offset:256
    ds_read_b64_tr_b16 v[60:61], v14 offset:0
    ds_read_b64_tr_b16 v[62:63], v14 offset:256
    s_waitcnt lgkmcnt(8)
    v_mfma_f32_16x16x32_bf16 v[96:99], v[32:35], v[16:19], v[96:99]
    ds_read_b128 v[64:67], v161 offset:0
    ds_read_b64_tr_b16 v[80:81], v162 offset:20480
    v_mfma_f32_16x16x32_bf16 v[104:107], v[36:39], v[16:19], v[104:107]
    ds_read_b64_tr_b16 v[82:83], v162 offset:20992
    ds_read_b128 v[68:71], v161 offset:2048
    v_mfma_f32_16x16x32_bf16 v[100:103], v[32:35], v[20:23], v[100:103]
    ds_read_b64_tr_b16 v[84:85], v163 offset:20480
    ds_read_b64_tr_b16 v[86:87], v163 offset:20992
    v_mfma_f32_16x16x32_bf16 v[108:111], v[36:39], v[20:23], v[108:111]
    ds_read_b128 v[72:75], v161 offset:4096
    ds_read_b128 v[76:79], v161 offset:6144
    v_mfma_f32_16x16x32_bf16 v[112:115], v[32:35], v[24:27], v[112:115]
    ds_read_b64_tr_b16 v[88:89], v164 offset:28672
    ds_read_b64_tr_b16 v[90:91], v164 offset:29184
    v_mfma_f32_16x16x32_bf16 v[120:123], v[36:39], v[24:27], v[120:123]
    ds_read_b64_tr_b16 v[92:93], v165 offset:28672
    ds_read_b64_tr_b16 v[94:95], v165 offset:29184
    v_mfma_f32_16x16x32_bf16 v[116:119], v[32:35], v[28:31], v[116:119]
    v_mfma_f32_16x16x32_bf16 v[124:127], v[36:39], v[28:31], v[124:127]
    s_waitcnt lgkmcnt(12)
    v_mfma_f32_16x16x32_bf16 v[128:131], v[16:19], v[40:43], v[128:131]
    v_mfma_f32_16x16x32_bf16 v[132:135], v[16:19], v[44:47], v[132:135]
    v_mfma_f32_16x16x32_bf16 v[136:139], v[20:23], v[40:43], v[136:139]
    v_mfma_f32_16x16x32_bf16 v[140:143], v[20:23], v[44:47], v[140:143]
    v_mfma_f32_16x16x32_bf16 v[144:147], v[24:27], v[40:43], v[144:147]
    v_mfma_f32_16x16x32_bf16 v[148:151], v[24:27], v[44:47], v[148:151]
    v_mfma_f32_16x16x32_bf16 v[152:155], v[28:31], v[40:43], v[152:155]
    v_mfma_f32_16x16x32_bf16 v[156:159], v[28:31], v[44:47], v[156:159]
    s_waitcnt lgkmcnt(4)
    v_mfma_f32_16x16x32_bf16 v[96:99], v[80:83], v[64:67], v[96:99]
    v_mfma_f32_16x16x32_bf16 v[104:107], v[84:87], v[64:67], v[104:107]
    s_waitcnt lgkmcnt(0)
    v_mfma_f32_16x16x32_bf16 v[100:103], v[80:83], v[68:71], v[100:103]
    s_barrier
    ds_read_b128 v[16:19], v160 offset:32768
    v_mfma_f32_16x16x32_bf16 v[108:111], v[84:87], v[68:71], v[108:111]
    ds_read_b64_tr_b16 v[32:33], v162 offset:49152
    v_mfma_f32_16x16x32_bf16 v[112:115], v[80:83], v[72:75], v[112:115]
    ds_read_b64_tr_b16 v[34:35], v162 offset:49664
    v_mfma_f32_16x16x32_bf16 v[120:123], v[84:87], v[72:75], v[120:123]
    ds_read_b128 v[20:23], v160 offset:34816
    v_mfma_f32_16x16x32_bf16 v[116:119], v[80:83], v[76:79], v[116:119]
    ds_read_b64_tr_b16 v[36:37], v163 offset:49152
    v_mfma_f32_16x16x32_bf16 v[124:127], v[84:87], v[76:79], v[124:127]
    ds_read_b64_tr_b16 v[38:39], v163 offset:49664
    v_mfma_f32_16x16x32_bf16 v[128:131], v[64:67], v[88:91], v[128:131]
    ds_read_b128 v[24:27], v160 offset:36864
    v_mfma_f32_16x16x32_bf16 v[132:135], v[64:67], v[92:95], v[132:135]
    ds_read_b128 v[28:31], v160 offset:38912
    v_mfma_f32_16x16x32_bf16 v[136:139], v[68:71], v[88:91], v[136:139]
    ds_read_b64_tr_b16 v[40:41], v164 offset:57344
    v_mfma_f32_16x16x32_bf16 v[140:143], v[68:71], v[92:95], v[140:143]
    ds_read_b64_tr_b16 v[42:43], v164 offset:57856
    v_mfma_f32_16x16x32_bf16 v[144:147], v[72:75], v[88:91], v[144:147]
    ds_read_b64_tr_b16 v[44:45], v165 offset:57344
    v_mfma_f32_16x16x32_bf16 v[148:151], v[72:75], v[92:95], v[148:151]
    ds_read_b64_tr_b16 v[46:47], v165 offset:57856
    v_mfma_f32_16x16x32_bf16 v[152:155], v[76:79], v[88:91], v[152:155]
    v_mfma_f32_16x16x32_bf16 v[156:159], v[76:79], v[92:95], v[156:159]
    s_not_b64 exec, s[28:29]
    v_mov_b64 v[56:57], 0
    v_mov_b64 v[58:59], 0
    s_mov_b64 exec, s[28:29]
    v_mov_b64 v[60:61], 0
    v_mov_b64 v[62:63], 0
    s_mov_b64 exec, -1
    ds_read_b64 v[12:13], v15
    s_waitcnt lgkmcnt(5)
    v_mfma_f32_16x16x32_bf16 v[96:99], v[32:35], v[16:19], v[96:99]
    ds_read_b128 v[64:67], v161 offset:32768
    ds_read_b64_tr_b16 v[80:81], v162 offset:53248
    v_mfma_f32_16x16x32_bf16 v[100:103], v[32:35], v[20:23], v[100:103]
    ds_read_b64_tr_b16 v[82:83], v162 offset:53760
    ds_read_b128 v[68:71], v161 offset:34816
    v_mfma_f32_16x16x32_bf16 v[108:111], v[36:39], v[20:23], v[108:111]
    ds_read_b64_tr_b16 v[84:85], v163 offset:53248
    ds_read_b64_tr_b16 v[86:87], v163 offset:53760
    v_mfma_f32_16x16x32_bf16 v[104:107], v[36:39], v[16:19], v[104:107]
    ds_read_b128 v[72:75], v161 offset:36864
    ds_read_b128 v[76:79], v161 offset:38912
    v_mfma_f32_16x16x32_bf16 v[120:123], v[36:39], v[24:27], v[120:123]
    ds_read_b64_tr_b16 v[88:89], v164 offset:61440
    ds_read_b64_tr_b16 v[90:91], v164 offset:61952
    v_mfma_f32_16x16x32_bf16 v[112:115], v[32:35], v[24:27], v[112:115]
    ds_read_b64_tr_b16 v[92:93], v165 offset:61440
    ds_read_b64_tr_b16 v[94:95], v165 offset:61952
    v_mfma_f32_16x16x32_bf16 v[116:119], v[32:35], v[28:31], v[116:119]
    v_mfma_f32_16x16x32_bf16 v[124:127], v[36:39], v[28:31], v[124:127]
    s_waitcnt lgkmcnt(9)
    v_mfma_f32_16x16x32_bf16 v[96:99], v[80:83], v[64:67], v[96:99]
    s_waitcnt lgkmcnt(8)
    v_mfma_f32_16x16x32_bf16 v[100:103], v[80:83], v[68:71], v[100:103]
    s_waitcnt lgkmcnt(6)
    v_mfma_f32_16x16x32_bf16 v[108:111], v[84:87], v[68:71], v[108:111]
    v_readfirstlane_b32 s60, v12
    v_readfirstlane_b32 s61, v13
    v_mfma_f32_16x16x32_bf16 v[104:107], v[84:87], v[64:67], v[104:107]
    s_waitcnt lgkmcnt(0)
    v_mfma_f32_16x16x32_bf16 v[120:123], v[84:87], v[72:75], v[120:123]
    s_add_u32 s24, s2, s60
    s_and_b32 s24, s24, 7
    s_cmp_lg_u32 s24, s99
    s_cbranch_scc1 L_wrong
    s_barrier
    v_mfma_f32_16x16x32_bf16 v[112:115], v[80:83], v[72:75], v[112:115]
    v_mfma_f32_16x16x32_bf16 v[116:119], v[80:83], v[76:79], v[116:119]
    v_mfma_f32_16x16x32_bf16 v[124:127], v[84:87], v[76:79], v[124:127]
    s_lshr_b32 s24, s61, 14
    s_and_b32 s61, s61, 0xffff
    s_cmp_le_u32 s24, s61
    s_cbranch_scc1 L_plc
    s_add_u32 s52, s52, 8192
    s_addc_u32 s53, s53, 0
    s_sub_u32 s6, s6, 8192
    s_lshl_b32 s24, s38, 13
    s_sub_u32 s31, s31, s24
L_plc:
    s_mov_b32 s61, s60
    s_cmp_eq_u32 s38, 1
    s_cbranch_scc1 L_epA
    v_mfma_f32_16x16x32_bf16 v[128:131], v[16:19], v[40:43], v[128:131]
    v_mfma_f32_16x16x32_bf16 v[132:135], v[16:19], v[44:47], v[132:135]
    v_mfma_f32_16x16x32_bf16 v[136:139], v[20:23], v[40:43], v[136:139]
    v_cvt_pk_bf16_f32 v160, v96, v97
    v_cvt_pk_bf16_f32 v161, v98, v99
    v_mfma_f32_16x16x32_bf16 v[140:143], v[20:23], v[44:47], v[140:143]
    v_cvt_pk_bf16_f32 v162, v100, v101
    v_cvt_pk_bf16_f32 v163, v102, v103
    v_mfma_f32_16x16x32_bf16 v[128:131], v[64:67], v[88:91], v[128:131]
    v_cvt_pk_bf16_f32 v164, v104, v105
    v_cvt_pk_bf16_f32 v165, v106, v107
    v_mfma_f32_16x16x32_bf16 v[132:135], v[64:67], v[92:95], v[132:135]
    v_cvt_pk_bf16_f32 v166, v108, v109
    v_cvt_pk_bf16_f32 v167, v110, v111
    v_mfma_f32_16x16x32_bf16 v[136:139], v[68:71], v[88:91], v[136:139]
    v_permlane16_swap_b32 v160, v162
    v_permlane16_swap_b32 v161, v163
    v_mfma_f32_16x16x32_bf16 v[140:143], v[68:71], v[92:95], v[140:143]
    v_permlane16_swap_b32 v164, v166
    v_permlane16_swap_b32 v165, v167
    v_mfma_f32_16x16x32_bf16 v[144:147], v[24:27], v[40:43], v[144:147]
    v_cvt_pk_bf16_f32 v168, v112, v113
    v_cvt_pk_bf16_f32 v169, v114, v115
    v_mfma_f32_16x16x32_bf16 v[148:151], v[24:27], v[44:47], v[148:151]
    v_cvt_pk_bf16_f32 v170, v116, v117
    v_cvt_pk_bf16_f32 v171, v118, v119
    v_mfma_f32_16x16x32_bf16 v[152:155], v[28:31], v[40:43], v[152:155]
    v_cvt_pk_bf16_f32 v172, v120, v121
    v_cvt_pk_bf16_f32 v173, v122, v123
    v_mfma_f32_16x16x32_bf16 v[156:159], v[28:31], v[44:47], v[156:159]
    v_cvt_pk_bf16_f32 v174, v124, v125
    v_cvt_pk_bf16_f32 v175, v126, v127
    v_mfma_f32_16x16x32_bf16 v[144:147], v[72:75], v[88:91], v[144:147]
    v_permlane16_swap_b32 v168, v170
    v_permlane16_swap_b32 v169, v171
    v_mfma_f32_16x16x32_bf16 v[148:151], v[72:75], v[92:95], v[148:151]
    v_permlane16_swap_b32 v172, v174
    v_permlane16_swap_b32 v173, v175
    v_mfma_f32_16x16x32_bf16 v[152:155], v[76:79], v[88:91], v[152:155]
    v_cvt_pk_bf16_f32 v176, v128, v129
    v_cvt_pk_bf16_f32 v177, v130, v131
    v_mfma_f32_16x16x32_bf16 v[156:159], v[76:79], v[92:95], v[156:159]
    v_cvt_pk_bf16_f32 v178, v132, v133
    v_cvt_pk_bf16_f32 v179, v134, v135
    v_cvt_pk_bf16_f32 v180, v136, v137
    v_cvt_pk_bf16_f32 v181, v138, v139
    v_cvt_pk_bf16_f32 v182, v140, v141
    v_cvt_pk_bf16_f32 v183, v142, v143
    v_permlane16_swap_b32 v176, v178
    v_permlane16_swap_b32 v177, v179
    v_permlane16_swap_b32 v180, v182
    v_permlane16_swap_b32 v181, v183
    v_permlane32_swap_b32 v176, v178
    v_permlane32_swap_b32 v177, v179
    v_permlane32_swap_b32 v180, v182
    v_permlane32_swap_b32 v181, v183
    v_cvt_pk_bf16_f32 v184, v144, v145
    v_cvt_pk_bf16_f32 v185, v146, v147
    v_cvt_pk_bf16_f32 v186, v148, v149
    v_cvt_pk_bf16_f32 v187, v150, v151
    v_cvt_pk_bf16_f32 v188, v152, v153
    v_cvt_pk_bf16_f32 v189, v154, v155
    v_cvt_pk_bf16_f32 v190, v156, v157
    v_cvt_pk_bf16_f32 v191, v158, v159
    v_permlane16_swap_b32 v184, v186
    v_permlane16_swap_b32 v185, v187
    v_permlane16_swap_b32 v188, v190
    v_permlane16_swap_b32 v189, v191
    v_permlane32_swap_b32 v184, v186
    v_permlane32_swap_b32 v185, v187
    v_permlane32_swap_b32 v188, v190
    v_permlane32_swap_b32 v189, v191
    v_mov_b32 v2, 149376
    s_mov_b32 s3, 262144
L_sp5:
    s_sleep 1
    s_sub_u32 s3, s3, 1
    ds_read_b32 v3, v2 offset:12
    s_waitcnt lgkmcnt(0)
    v_cmp_gt_u32 vcc, 4, v3
    s_cselect_b64 vcc, 0, vcc
    s_cbranch_vccnz L_sp5
    buffer_store_dwordx4 v[160:163], v8, s[52:55], s32 offen offset:0 sc1
    buffer_store_dwordx4 v[164:167], v8, s[52:55], s30 offen offset:0 sc1
    buffer_store_dwordx4 v[168:171], v8, s[52:55], s32 offen offset:1024 sc1
    buffer_store_dwordx4 v[172:175], v8, s[52:55], s30 offen offset:1024 sc1
    buffer_store_dwordx4 v[176:179], v52, s[52:55], s31 offen offset:0 sc1
    buffer_store_dwordx4 v[180:183], v52, s[52:55], s31 offen offset:512 sc1
    buffer_store_dwordx4 v[184:187], v52, s[52:55], s31 offen offset:1024 sc1
    buffer_store_dwordx4 v[188:191], v52, s[52:55], s31 offen offset:1536 sc1
    v_mov_b32 v2, s60
    v_mov_b32 v3, s61
    v_mov_b32 v4, s60
    v_mov_b32 v5, s61
    s_waitcnt vmcnt(0)
    s_mov_b64 exec, 0xff
    buffer_store_dwordx4 v[2:5], v8, s[52:55], s34 offen sc1
    s_mov_b64 exec, -1
    s_cmp_lt_u32 s39, 2
    s_cbranch_scc1 L_nbB
L_nb2B:
    s_cmp_eq_u32 s43, 1
    s_cbranch_scc1 L_epB1
    ds_write_b128 v54, v[160:163] offset:0
    ds_write_b128 v53, v[176:179] offset:0
    ds_write_b128 v54, v[164:167] offset:12288
    ds_write_b128 v53, v[180:183] offset:512
    ds_write_b128 v54, v[168:171] offset:1024
    ds_write_b128 v53, v[184:187] offset:1024
    ds_write_b128 v54, v[172:175] offset:13312
    ds_write_b128 v53, v[188:191] offset:1536
L_epB1:
    s_cmp_eq_u32 s39, 0
    s_cbranch_scc1 L_epB2
    v_and_b32 v55, 1, v1
    v_lshlrev_b32 v55, 7, v55
    s_mov_b64 exec, 3
    v_add_u32 v55, s9, v55
    s_mov_b64 exec, 12
    v_add_u32 v55, s10, v55
    s_mov_b64 exec, 48
    v_add_u32 v55, s11, v55
    s_mov_b64 exec, -1
    s_mov_b64 exec, 15
    buffer_load_dword v250, v55, s[52:55], 0 offen sc1
    s_mov_b64 exec, -1
    s_mov_b64 exec, 15
    s_waitcnt vmcnt(0)
    v_cmp_ne_u32 vcc, s60, v250
    s_cbranch_vccz L_pd6
    s_mov_b32 s3, 65536
L_pl6:
    s_sleep 2
    buffer_load_dword v250, v55, s[52:55], 0 offen sc1
    s_sub_u32 s3, s3, 1
    s_waitcnt vmcnt(0)
    v_cmp_ne_u32 vcc, s60, v250
    s_cselect_b64 vcc, 0, vcc
    s_cbranch_vccnz L_pl6
L_pd6:
    s_mov_b64 exec, -1
    s_cmp_lt_u32 s39, 2
    s_cbranch_scc1 L_sk0B
    s_sub_u32 s25, s33, 524288
    s_add_u32 m0, s27, 0
    s_nop 0
    buffer_load_dwordx4 v8, s[52:55], s25 offen offset:0 sc1 lds
    buffer_load_dwordx4 v8, s[52:55], s25 offen offset:1024 sc1 lds
    buffer_load_dwordx4 v8, s[52:55], s25 offen offset:2048 sc1 lds
    buffer_load_dwordx4 v8, s[52:55], s25 offen offset:3072 sc1 lds
L_sk0B:
    s_cmp_lt_u32 s39, 1
    s_cbranch_scc1 L_sk1B
    s_sub_u32 s25, s33, 262144
    s_add_u32 m0, s27, 4096
    s_nop 0
    buffer_load_dwordx4 v8, s[52:55], s25 offen offset:0 sc1 lds
    buffer_load_dwordx4 v8, s[52:55], s25 offen offset:1024 sc1 lds
    buffer_load_dwordx4 v8, s[52:55], s25 offen offset:2048 sc1 lds
    buffer_load_dwordx4 v8, s[52:55], s25 offen offset:3072 sc1 lds
L_sk1B:
L_epB2:
    s_waitcnt vmcnt(0) lgkmcnt(0)
    s_branch L_e1
L_epA:
L_chain4:
L_pad4:
    s_cbranch_execz L_pad8
    v_mfma_f32_16x16x32_bf16 v[128:131], v[16:19], v[40:43], v[128:131]
    v_cvt_pk_bf16_f32 v160, v96, v97
    v_cvt_pk_bf16_f32 v161, v98, v99
    v_mfma_f32_16x16x32_bf16 v[132:135], v[16:19], v[44:47], v[132:135]
    v_cvt_pk_bf16_f32 v162, v100, v101
    v_cvt_pk_bf16_f32 v163, v102, v103
    v_mfma_f32_16x16x32_bf16 v[136:139], v[20:23], v[40:43], v[136:139]
    v_cvt_pk_bf16_f32 v164, v104, v105
    v_cvt_pk_bf16_f32 v165, v106, v107
    v_mfma_f32_16x16x32_bf16 v[140:143], v[20:23], v[44:47], v[140:143]
    v_cvt_pk_bf16_f32 v166, v108, v109
    v_cvt_pk_bf16_f32 v167, v110, v111
    v_mfma_f32_16x16x32_bf16 v[144:147], v[24:27], v[40:43], v[144:147]
    v_permlane16_swap_b32 v160, v162
    v_permlane16_swap_b32 v161, v163
    v_mfma_f32_16x16x32_bf16 v[148:151], v[24:27], v[44:47], v[148:151]
    v_permlane16_swap_b32 v164, v166
    v_permlane16_swap_b32 v165, v167
    v_mfma_f32_32x32x16_bf16 v[96:111], v[56:59], v[160:163], 0
    v_cvt_pk_bf16_f32 v208, v112, v113
    v_cvt_pk_bf16_f32 v209, v114, v115
    v_cvt_pk_bf16_f32 v210, v116, v117
    v_cvt_pk_bf16_f32 v211, v118, v119
    v_cvt_pk_bf16_f32 v212, v120, v121
    v_cvt_pk_bf16_f32 v213, v122, v123
    v_mfma_f32_32x32x16_bf16 v[96:111], v[60:63], v[164:167], v[96:111]
    v_cvt_pk_bf16_f32 v214, v124, v125
    v_cvt_pk_bf16_f32 v215, v126, v127
    v_permlane16_swap_b32 v208, v210
    v_permlane16_swap_b32 v209, v211
    v_permlane16_swap_b32 v212, v214
    v_permlane16_swap_b32 v213, v215
    v_mfma_f32_32x32x16_bf16 v[112:127], v[56:59], v[208:211], 0
    s_nop 0
    v_mfma_f32_32x32x16_bf16 v[112:127], v[60:63], v[212:215], v[112:127]
    v_mfma_f32_16x16x32_bf16 v[152:155], v[28:31], v[40:43], v[152:155]
    v_mfma_f32_16x16x32_bf16 v[156:159], v[28:31], v[44:47], v[156:159]
    v_mov_b32 v6, 0
    s_lshl_b32 s25, s41, 2
    s_add_u32 s25, s25, 149408
    v_mul_f32 v96, s62, v96
    s_nop 5
    v_mul_f32 v112, s62, v112
    v_mul_f32 v97, s62, v97
    v_mul_f32 v113, s62, v113
    v_mfma_f32_16x16x32_bf16 v[128:131], v[64:67], v[88:91], v[128:131]
    v_mfma_f32_16x16x32_bf16 v[132:135], v[64:67], v[92:95], v[132:135]
    v_mul_f32 v98, s62, v98
    v_mul_f32 v114, s62, v114
    v_mul_f32 v99, s62, v99
    v_mul_f32 v115, s62, v115
    v_mfma_f32_16x16x32_bf16 v[136:139], v[68:71], v[88:91], v[136:139]
    v_mfma_f32_16x16x32_bf16 v[140:143], v[68:71], v[92:95], v[140:143]
    v_mul_f32 v100, s62, v100
    v_mul_f32 v116, s62, v116
    v_mul_f32 v101, s62, v101
    v_mul_f32 v117, s62, v117
    v_mfma_f32_16x16x32_bf16 v[144:147], v[72:75], v[88:91], v[144:147]
    v_mfma_f32_16x16x32_bf16 v[148:151], v[72:75], v[92:95], v[148:151]
    v_mul_f32 v102, s62, v102
    v_mul_f32 v118, s62, v118
    v_mul_f32 v103, s62, v103
    v_mul_f32 v119, s62, v119
    v_mfma_f32_16x16x32_bf16 v[152:155], v[76:79], v[88:91], v[152:155]
    v_mfma_f32_16x16x32_bf16 v[156:159], v[76:79], v[92:95], v[156:159]
    v_exp_f32_e64 v16, -v96
    v_exp_f32_e64 v24, -v112
    v_exp_f32 v96, v96
    v_exp_f32 v112, v112
    v_exp_f32_e64 v17, -v97
    v_exp_f32_e64 v25, -v113
    v_exp_f32 v97, v97
    v_exp_f32 v113, v113
    v_exp_f32_e64 v18, -v98
    v_exp_f32_e64 v26, -v114
    v_exp_f32 v98, v98
    v_exp_f32 v114, v114
    v_exp_f32_e64 v19, -v99
    v_exp_f32_e64 v27, -v115
    v_exp_f32 v99, v99
    v_exp_f32 v115, v115
    v_exp_f32_e64 v20, -v100
    v_exp_f32_e64 v28, -v116
    v_exp_f32 v100, v100
    v_exp_f32 v116, v116
    v_exp_f32_e64 v21, -v101
    v_exp_f32_e64 v29, -v117
    v_exp_f32 v101, v101
    v_exp_f32 v117, v117
    v_exp_f32_e64 v22, -v102
    v_exp_f32_e64 v30, -v118
    v_exp_f32 v102, v102
    v_exp_f32 v118, v118
    v_exp_f32_e64 v23, -v103
    v_exp_f32_e64 v31, -v119
    v_exp_f32 v103, v103
    v_exp_f32 v119, v119
    v_add_f32 v2, v96, v97
    v_add_f32 v4, v112, v113
    v_add_f32 v3, v16, v17
    v_add_f32 v5, v24, v25
    v_add_f32 v2, v2, v98
L_chain5:
L_pad5:
    s_cbranch_execz L_pad9
    v_add_f32 v4, v4, v114
    v_add_f32 v3, v3, v18
    v_add_f32 v5, v5, v26
    s_cmp_lt_u32 s39, 2
    s_cbranch_scc1 L_nbA
L_nb2A:
    v_cvt_pk_bf16_f32 v184, v128, v129
    v_cvt_pk_bf16_f32 v185, v130, v131
    v_cvt_pk_bf16_f32 v186, v132, v133
    v_cvt_pk_bf16_f32 v187, v134, v135
    v_cvt_pk_bf16_f32 v188, v136, v137
    v_cvt_pk_bf16_f32 v189, v138, v139
    v_cvt_pk_bf16_f32 v190, v140, v141
    v_cvt_pk_bf16_f32 v191, v142, v143
    v_permlane16_swap_b32 v184, v186
    v_permlane16_swap_b32 v185, v187
    v_permlane16_swap_b32 v188, v190
    v_permlane16_swap_b32 v189, v191
    v_permlane32_swap_b32 v184, v186
    v_permlane32_swap_b32 v185, v187
    v_permlane32_swap_b32 v188, v190
    v_permlane32_swap_b32 v189, v191
    v_cvt_pk_bf16_f32 v192, v144, v145
    v_cvt_pk_bf16_f32 v193, v146, v147
    v_cvt_pk_bf16_f32 v194, v148, v149
    v_cvt_pk_bf16_f32 v195, v150, v151
    v_cvt_pk_bf16_f32 v196, v152, v153
    v_cvt_pk_bf16_f32 v197, v154, v155
    v_cvt_pk_bf16_f32 v198, v156, v157
    v_cvt_pk_bf16_f32 v199, v158, v159
    v_permlane16_swap_b32 v192, v194
    v_permlane16_swap_b32 v193, v195
    v_permlane16_swap_b32 v196, v198
    v_permlane16_swap_b32 v197, v199
    v_permlane32_swap_b32 v192, v194
    v_permlane32_swap_b32 v193, v195
    v_permlane32_swap_b32 v196, v198
    v_permlane32_swap_b32 v197, v199
    s_mov_b64 exec, s[28:29]
    v_mov_b64 v[168:169], v[184:185]
    v_mov_b64 v[170:171], v[186:187]
    v_mov_b64 v[172:173], v[188:189]
    v_mov_b64 v[174:175], v[190:191]
    v_mov_b64 v[176:177], v[192:193]
    v_mov_b64 v[178:179], v[194:195]
    v_mov_b64 v[180:181], v[196:197]
    v_mov_b64 v[182:183], v[198:199]
    v_mov_b64 v[184:185], v[240:241]
    v_mov_b64 v[186:187], v[240:241]
    v_mov_b64 v[188:189], v[240:241]
    v_mov_b64 v[190:191], v[240:241]
    v_mov_b64 v[192:193], v[240:241]
    v_mov_b64 v[194:195], v[240:241]
    v_mov_b64 v[196:197], v[240:241]
    v_mov_b64 v[198:199], v[240:241]
    s_mov_b64 exec, -1
    v_mov_b32 v48, s25
    v_xor_b32 v49, 8, v48
    v_add_f32 v2, v2, v99
    v_add_f32 v4, v4, v115
    v_mul_f32 v104, s62, v104
    v_mul_f32 v120, s62, v120
    v_add_f32 v3, v3, v19
    v_add_f32 v5, v5, v27
    v_mul_f32 v105, s62, v105
    v_mul_f32 v121, s62, v121
    v_add_f32 v2, v2, v100
    v_add_f32 v4, v4, v116
    v_mul_f32 v106, s62, v106
    v_mul_f32 v122, s62, v122
    v_add_f32 v3, v3, v20
    v_add_f32 v5, v5, v28
    v_mul_f32 v107, s62, v107
    v_mul_f32 v123, s62, v123
    v_add_f32 v2, v2, v101
    v_add_f32 v4, v4, v117
    v_mul_f32 v108, s62, v108
    v_mul_f32 v124, s62, v124
    v_add_f32 v3, v3, v21
    v_add_f32 v5, v5, v29
    v_mul_f32 v109, s62, v109
    v_mul_f32 v125, s62, v125
    v_add_f32 v2, v2, v102
    v_add_f32 v4, v4, v118
    v_mul_f32 v110, s62, v110
    v_mul_f32 v126, s62, v126
    v_add_f32 v3, v3, v22
    v_add_f32 v5, v5, v30
    v_mul_f32 v111, s62, v111
    v_mul_f32 v127, s62, v127
    v_add_f32 v2, v2, v103
    v_add_f32 v4, v4, v119
    v_exp_f32_e64 v32, -v104
    v_exp_f32_e64 v40, -v120
    v_add_f32 v3, v3, v23
    v_add_f32 v5, v5, v31
    v_exp_f32 v104, v104
    v_exp_f32 v120, v120
    v_permlane32_swap_b32 v2, v3
    v_permlane32_swap_b32 v4, v5
    v_exp_f32_e64 v33, -v105
    v_exp_f32_e64 v41, -v121
    v_add_f32 v2, v2, v3
    v_add_f32 v4, v4, v5
    v_exp_f32 v105, v105
    v_exp_f32 v121, v121
    v_max_f32 v6, v6, v2
    v_max_f32 v6, v6, v4
    v_exp_f32_e64 v34, -v106
    v_exp_f32_e64 v42, -v122
    v_rcp_f32 v2, v2
    v_rcp_f32 v4, v4
    v_exp_f32 v106, v106
    v_exp_f32 v122, v122
    v_mov_b32 v3, v2
    v_mov_b32 v5, v4
    v_exp_f32_e64 v35, -v107
    v_exp_f32_e64 v43, -v123
    v_permlane32_swap_b32 v2, v3
    v_permlane32_swap_b32 v4, v5
    v_exp_f32 v107, v107
    v_exp_f32 v123, v123
    v_mul_f32 v96, v96, v2
    v_mul_f32 v112, v112, v4
    v_exp_f32_e64 v36, -v108
    v_exp_f32_e64 v44, -v124
    v_mul_f32 v97, v97, v2
    v_mul_f32 v113, v113, v4
    v_exp_f32 v108, v108
    v_exp_f32 v124, v124
    v_mul_f32 v98, v98, v2
    v_mul_f32 v114, v114, v4
    v_exp_f32_e64 v37, -v109
    v_exp_f32_e64 v45, -v125
    v_mul_f32 v99, v99, v2
    v_mul_f32 v115, v115, v4
    v_exp_f32 v109, v109
    v_exp_f32 v125, v125
    v_mul_f32 v100, v100, v2
    v_mul_f32 v116, v116, v4
    v_exp_f32_e64 v38, -v110
    v_exp_f32_e64 v46, -v126
    v_mul_f32 v101, v101, v2
    v_mul_f32 v117, v117, v4
    v_exp_f32 v110, v110
    v_exp_f32 v126, v126
    v_mul_f32 v102, v102, v2
    v_mul_f32 v118, v118, v4
    v_exp_f32_e64 v39, -v111
    v_exp_f32_e64 v47, -v127
    v_mul_f32 v103, v103, v2
    v_mul_f32 v119, v119, v4
    v_exp_f32 v111, v111
    v_exp_f32 v127, v127
    v_cvt_pk_bf16_f32 v96, v96, v97
    v_cvt_pk_bf16_f32 v112, v112, v113
    v_add_f32 v12, v104, v105
    v_add_f32 v14, v120, v121
    v_cvt_pk_bf16_f32 v97, v98, v99
    v_cvt_pk_bf16_f32 v113, v114, v115
    v_add_f32 v13, v32, v33
    v_add_f32 v15, v40, v41
    v_cvt_pk_bf16_f32 v98, v100, v101
    v_cvt_pk_bf16_f32 v114, v116, v117
    v_add_f32 v12, v12, v106
    v_add_f32 v14, v14, v122
    v_cvt_pk_bf16_f32 v99, v102, v103
    v_cvt_pk_bf16_f32 v115, v118, v119
    v_add_f32 v13, v13, v34
    v_add_f32 v15, v15, v42
    v_mul_f32 v16, v16, v3
    v_mul_f32 v24, v24, v5
    v_add_f32 v12, v12, v107
    v_add_f32 v14, v14, v123
    v_mul_f32 v17, v17, v3
    v_mul_f32 v25, v25, v5
    v_add_f32 v13, v13, v35
    v_add_f32 v15, v15, v43
    v_mfma_f32_32x32x16_bf16 v[64:79], v[96:99], v[200:203], 0
    v_mfma_f32_32x32x16_bf16 v[80:95], v[112:115], v[200:203], 0
    v_add_f32 v12, v12, v108
    v_add_f32 v14, v14, v124
    v_mul_f32 v18, v18, v3
    v_mul_f32 v26, v26, v5
    v_add_f32 v13, v13, v36
    v_add_f32 v15, v15, v44
    v_mul_f32 v19, v19, v3
    v_mul_f32 v27, v27, v5
    v_add_f32 v12, v12, v109
    v_add_f32 v14, v14, v125
    v_mul_f32 v20, v20, v3
    v_mul_f32 v28, v28, v5
    v_add_f32 v13, v13, v37
    v_add_f32 v15, v15, v45
    v_mul_f32 v21, v21, v3
    v_mul_f32 v29, v29, v5
    v_add_f32 v12, v12, v110
    v_add_f32 v14, v14, v126
    v_mul_f32 v22, v22, v3
    v_mul_f32 v30, v30, v5
    v_add_f32 v13, v13, v38
    v_add_f32 v15, v15, v46
    v_mul_f32 v23, v23, v3
    v_mul_f32 v31, v31, v5
    v_add_f32 v12, v12, v111
    v_add_f32 v14, v14, v127
    v_cvt_pk_bf16_f32 v16, v16, v17
    v_cvt_pk_bf16_f32 v24, v24, v25
    v_add_f32 v13, v13, v39
    v_add_f32 v15, v15, v47
    v_cvt_pk_bf16_f32 v17, v18, v19
    v_cvt_pk_bf16_f32 v25, v26, v27
    v_permlane32_swap_b32 v12, v13
    v_permlane32_swap_b32 v14, v15
    v_cvt_pk_bf16_f32 v18, v20, v21
    v_cvt_pk_bf16_f32 v26, v28, v29
    v_add_f32 v12, v12, v13
    v_add_f32 v14, v14, v15
    v_cvt_pk_bf16_f32 v19, v22, v23
    v_cvt_pk_bf16_f32 v27, v30, v31
    v_max_f32 v6, v6, v12
    v_max_f32 v6, v6, v14
    v_rcp_f32 v12, v12
    v_rcp_f32 v14, v14
    v_mfma_f32_32x32x16_bf16 v[64:79], v[16:19], v[204:207], v[64:79]
    v_mfma_f32_32x32x16_bf16 v[80:95], v[24:27], v[204:207], v[80:95]
    v_mov_b32 v13, v12
    v_mov_b32 v15, v14
    s_nop 0
    v_permlane32_swap_b32 v12, v13
    v_permlane32_swap_b32 v14, v15
    v_mul_f32 v104, v104, v12
    v_mul_f32 v120, v120, v14
    v_mul_f32 v105, v105, v12
    v_mul_f32 v121, v121, v14
    v_mul_f32 v106, v106, v12
    v_mul_f32 v122, v122, v14
    v_mul_f32 v107, v107, v12
    v_mul_f32 v123, v123, v14
    v_mul_f32 v108, v108, v12
    v_mul_f32 v124, v124, v14
    v_cvt_pk_bf16_f32 v64, v64, v65
    v_cvt_pk_bf16_f32 v65, v66, v67
    v_cvt_pk_bf16_f32 v66, v68, v69
    v_cvt_pk_bf16_f32 v67, v70, v71
    v_cvt_pk_bf16_f32 v68, v72, v73
    v_cvt_pk_bf16_f32 v69, v74, v75
    v_cvt_pk_bf16_f32 v70, v76, v77
    v_cvt_pk_bf16_f32 v71, v78, v79
    v_cvt_pk_bf16_f32 v72, v80, v81
    v_cvt_pk_bf16_f32 v73, v82, v83
    v_cvt_pk_bf16_f32 v74, v84, v85
    v_cvt_pk_bf16_f32 v75, v86, v87
    v_cvt_pk_bf16_f32 v76, v88, v89
    v_cvt_pk_bf16_f32 v77, v90, v91
    v_cvt_pk_bf16_f32 v78, v92, v93
    v_cvt_pk_bf16_f32 v79, v94, v95
    v_mul_f32 v109, v109, v12
    v_mul_f32 v125, v125, v14
    v_mul_f32 v110, v110, v12
    v_mul_f32 v126, v126, v14
    s_waitcnt lgkmcnt(0)
    v_mfma_f32_32x32x16_bf16 v[128:143], v[168:171], v[64:67], 0
    v_mul_f32 v111, v111, v12
    v_mul_f32 v127, v127, v14
    v_mfma_f32_32x32x16_bf16 v[128:143], v[172:175], v[68:71], v[128:143]
    v_cvt_pk_bf16_f32 v104, v104, v105
    v_cvt_pk_bf16_f32 v120, v120, v121
    v_cvt_pk_bf16_f32 v105, v106, v107
    v_cvt_pk_bf16_f32 v121, v122, v123
    v_mfma_f32_32x32x16_bf16 v[128:143], v[176:179], v[72:75], v[128:143]
    v_cvt_pk_bf16_f32 v106, v108, v109
    v_cvt_pk_bf16_f32 v122, v124, v125
    v_cvt_pk_bf16_f32 v107, v110, v111
    v_cvt_pk_bf16_f32 v123, v126, v127
    v_mfma_f32_32x32x16_bf16 v[128:143], v[180:183], v[76:79], v[128:143]
    v_mul_f32 v32, v32, v13
    v_mul_f32 v40, v40, v15
    v_mul_f32 v33, v33, v13
    v_mul_f32 v41, v41, v15
    v_mfma_f32_32x32x16_bf16 v[80:95], v[104:107], v[200:203], 0
    v_mfma_f32_32x32x16_bf16 v[16:31], v[120:123], v[200:203], 0
    v_mul_f32 v34, v34, v13
    v_mul_f32 v42, v42, v15
    v_cmp_ngt_f32 vcc, s63, v6
    s_cbranch_vccnz L_kexa
    s_nop 1
    ds_write_b128 v52, v[128:131]
    ds_write_b128 v52, v[132:135] offset:1024
    ds_write_b32 v52, v136 offset:2048
    ds_write_b32 v48, v243
    v_mul_f32 v35, v35, v13
    v_mul_f32 v43, v43, v15
    v_mul_f32 v36, v36, v13
    v_mul_f32 v44, v44, v15
    v_mul_f32 v37, v37, v13
    v_mul_f32 v45, v45, v15
    v_mul_f32 v38, v38, v13
    v_mul_f32 v46, v46, v15
    v_mul_f32 v39, v39, v13
    v_mul_f32 v47, v47, v15
    v_cvt_pk_bf16_f32 v32, v32, v33
    v_cvt_pk_bf16_f32 v40, v40, v41
    v_cvt_pk_bf16_f32 v33, v34, v35
    v_cvt_pk_bf16_f32 v41, v42, v43
    v_cvt_pk_bf16_f32 v34, v36, v37
    v_cvt_pk_bf16_f32 v42, v44, v45
    v_cvt_pk_bf16_f32 v35, v38, v39
    v_cvt_pk_bf16_f32 v43, v46, v47
    s_nop 0
    v_mfma_f32_32x32x16_bf16 v[80:95], v[32:35], v[204:207], v[80:95]
    v_mfma_f32_32x32x16_bf16 v[16:31], v[40:43], v[204:207], v[16:31]
L_kdone:
    ds_read_b32 v50, v49
    ds_read_b128 v[152:155], v53
    ds_read_b128 v[156:159], v53 offset:1024
    ds_read_b32 v144, v53 offset:2048
    s_nop 6
    v_cvt_pk_bf16_f32 v80, v80, v81
    v_cvt_pk_bf16_f32 v81, v82, v83
    v_cvt_pk_bf16_f32 v82, v84, v85
    v_cvt_pk_bf16_f32 v83, v86, v87
    v_cvt_pk_bf16_f32 v84, v88, v89
    v_cvt_pk_bf16_f32 v85, v90, v91
    v_cvt_pk_bf16_f32 v86, v92, v93
    v_cvt_pk_bf16_f32 v87, v94, v95
    s_waitcnt lgkmcnt(0)
    v_cmp_eq_u32 vcc, 0, v50
    s_cbranch_vccnz L_exs
L_exd:
    v_mfma_f32_32x32x16_bf16 v[144:159], v[184:187], v[80:83], v[144:159]
    v_cvt_pk_bf16_f32 v16, v16, v17
    v_cvt_pk_bf16_f32 v17, v18, v19
    v_cvt_pk_bf16_f32 v18, v20, v21
    v_cvt_pk_bf16_f32 v19, v22, v23
    v_mfma_f32_32x32x16_bf16 v[144:159], v[188:191], v[84:87], v[144:159]
    v_cvt_pk_bf16_f32 v20, v24, v25
    v_cvt_pk_bf16_f32 v21, v26, v27
    v_cvt_pk_bf16_f32 v22, v28, v29
    v_cvt_pk_bf16_f32 v23, v30, v31
    v_mfma_f32_32x32x16_bf16 v[144:159], v[192:195], v[16:19], v[144:159]
    s_nop 0
    v_mfma_f32_32x32x16_bf16 v[144:159], v[196:199], v[20:23], v[144:159]
    v_and_b32 v55, 1, v1
    v_lshlrev_b32 v55, 7, v55
    s_mov_b64 exec, 3
    v_add_u32 v55, s9, v55
    s_mov_b64 exec, 12
    v_add_u32 v55, s10, v55
    s_mov_b64 exec, 48
    v_add_u32 v55, s11, v55
    s_mov_b64 exec, -1
    s_nop 2
    buffer_atomic_add_f32 v152, v54, s[52:55], s31 offen offset:0
    buffer_atomic_add_f32 v153, v54, s[52:55], s31 offen offset:128
    buffer_atomic_add_f32 v154, v54, s[52:55], s31 offen offset:256
    buffer_atomic_add_f32 v155, v54, s[52:55], s31 offen offset:384
    buffer_atomic_add_f32 v156, v54, s[52:55], s31 offen offset:1024
    buffer_atomic_add_f32 v157, v54, s[52:55], s31 offen offset:1152
    buffer_atomic_add_f32 v158, v54, s[52:55], s31 offen offset:1280
    buffer_atomic_add_f32 v159, v54, s[52:55], s31 offen offset:1408
    s_mov_b32 exec_hi, 0
    s_add_u32 s31, s31, 65536
    buffer_atomic_add_f32 v144, v54, s[52:55], s31 offen
    s_mov_b64 exec, -1
    s_mov_b64 exec, 63
    buffer_load_dword v250, v55, s[52:55], 0 offen sc1
    s_mov_b64 exec, -1
    s_waitcnt vmcnt(1)
    s_mov_b64 exec, 1
    buffer_atomic_add v243, v244, s[52:55], s31 offen offset:256
    s_mov_b64 exec, -1
    s_mov_b64 exec, 63
    s_waitcnt vmcnt(1)
    v_cmp_ne_u32 vcc, s60, v250
    s_cbranch_vccz L_pd7
    s_mov_b32 s3, 65536
L_pl7:
    s_sleep 2
    buffer_load_dword v250, v55, s[52:55], 0 offen sc1
    s_sub_u32 s3, s3, 1
    s_waitcnt vmcnt(0)
    v_cmp_ne_u32 vcc, s60, v250
    s_cselect_b64 vcc, 0, vcc
    s_cbranch_vccnz L_pl7
L_pd7:
    s_mov_b64 exec, -1
    s_cmp_lt_u32 s39, 2
    s_cbranch_scc1 L_sk0A
    s_sub_u32 s25, s33, 524288
    s_add_u32 m0, s27, 0
    s_nop 0
    buffer_load_dwordx4 v8, s[52:55], s25 offen offset:0 sc1 lds
    buffer_load_dwordx4 v8, s[52:55], s25 offen offset:1024 sc1 lds
    buffer_load_dwordx4 v8, s[52:55], s25 offen offset:2048 sc1 lds
    buffer_load_dwordx4 v8, s[52:55], s25 offen offset:3072 sc1 lds
L_sk0A:
    s_cmp_lt_u32 s39, 1
    s_cbranch_scc1 L_sk1A
    s_sub_u32 s25, s33, 262144
    s_add_u32 m0, s27, 4096
    s_nop 0
    buffer_load_dwordx4 v8, s[52:55], s25 offen offset:0 sc1 lds
    buffer_load_dwordx4 v8, s[52:55], s25 offen offset:1024 sc1 lds
    buffer_load_dwordx4 v8, s[52:55], s25 offen offset:2048 sc1 lds
    buffer_load_dwordx4 v8, s[52:55], s25 offen offset:3072 sc1 lds
L_sk1A:
    s_sub_u32 s25, s33, 0
    s_add_u32 m0, s27, 8192
    s_nop 0
    buffer_load_dwordx4 v8, s[52:55], s25 offen offset:0 sc1 lds
    buffer_load_dwordx4 v8, s[52:55], s25 offen offset:1024 sc1 lds
    buffer_load_dwordx4 v8, s[52:55], s25 offen offset:2048 sc1 lds
    buffer_load_dwordx4 v8, s[52:55], s25 offen offset:3072 sc1 lds
    s_waitcnt vmcnt(0)
L_e1:
    s_lshl_b32 s24, s41, 10
    v_add_u32 v9, s24, v249
    s_barrier
    ds_read_b128 v[28:31], v249
L_att:
L_chain6:
L_pad6:
    s_cbranch_execz L_pad10
    s_cmp_lt_u32 s39, 2
    s_cbranch_scc1 L_bslow
    ds_read_b128 v[176:179], v245 offset:8192
    ds_read_b128 v[144:147], v245 offset:0
    ds_read_b128 v[172:175], v245 offset:7168
    ds_read_b128 v[168:171], v245 offset:6144
    ds_read_b128 v[164:167], v245 offset:5120
    ds_read_b128 v[160:163], v245 offset:4096
    ds_read_b128 v[156:159], v245 offset:3072
    ds_read_b128 v[152:155], v245 offset:2048
    ds_read_b128 v[148:151], v245 offset:1024
    s_waitcnt lgkmcnt(8)
    v_mfma_f32_32x32x16_bf16 v[64:79], v[176:179], v[28:31], 0
    s_waitcnt lgkmcnt(7)
    v_mfma_f32_32x32x16_bf16 v[128:143], v[144:147], v[28:31], 0
    s_mov_b64 exec, s[28:29]
    ds_read_b128 v[216:219], v246 offset:8192
    ds_read_b128 v[220:223], v246 offset:8704
    ds_read_b128 v[224:227], v246 offset:0
    ds_read_b128 v[228:231], v246 offset:512
    s_mov_b64 exec, -1
    s_nop 5
    v_cndmask_b32_e64 v64, v128, v64, s[64:65]
    v_cndmask_b32_e64 v65, v129, v65, s[66:67]
    v_cndmask_b32_e64 v66, v130, v66, s[68:69]
    v_cndmask_b32_e64 v67, v131, v67, s[70:71]
    v_cndmask_b32_e64 v68, v132, v68, s[72:73]
    v_cndmask_b32_e64 v69, v133, v69, s[74:75]
    v_cndmask_b32_e64 v70, v134, v70, s[76:77]
    v_cndmask_b32_e64 v71, v135, v71, s[78:79]
    v_cndmask_b32_e64 v72, v136, v72, s[80:81]
    v_cndmask_b32_e64 v73, v137, v73, s[82:83]
    v_cndmask_b32_e64 v74, v138, v74, s[84:85]
    v_cndmask_b32_e64 v75, v139, v75, s[86:87]
    v_cndmask_b32_e64 v76, v140, v76, s[88:89]
    v_cndmask_b32_e64 v77, v141, v77, s[90:91]
    v_cndmask_b32_e64 v78, v142, v78, s[92:93]
    v_cndmask_b32_e64 v79, v143, v79, s[94:95]
    v_exp_f32 v64, v64
    s_waitcnt lgkmcnt(10)
    v_mfma_f32_32x32x16_bf16 v[80:95], v[172:175], v[28:31], 0
    v_exp_f32 v65, v65
    v_exp_f32 v66, v66
    v_exp_f32 v67, v67
    v_exp_f32 v68, v68
    v_exp_f32 v69, v69
    v_exp_f32 v70, v70
    v_exp_f32 v71, v71
    v_exp_f32 v72, v72
    s_waitcnt lgkmcnt(9)
    v_mfma_f32_32x32x16_bf16 v[96:111], v[168:171], v[28:31], 0
    v_exp_f32 v73, v73
    v_exp_f32 v74, v74
    v_exp_f32 v75, v75
    v_exp_f32 v76, v76
    v_exp_f32 v77, v77
    v_exp_f32 v78, v78
    v_exp_f32 v79, v79
    v_cvt_pk_bf16_f32 v64, v64, v65
    v_cvt_pk_bf16_f32 v65, v66, v67
    v_cvt_pk_bf16_f32 v66, v68, v69
    v_cvt_pk_bf16_f32 v67, v70, v71
    v_cvt_pk_bf16_f32 v68, v72, v73
    v_cvt_pk_bf16_f32 v69, v74, v75
    v_cvt_pk_bf16_f32 v70, v76, v77
    v_cvt_pk_bf16_f32 v71, v78, v79
    v_bfi_b32 v72, v232, 0, v64
    v_bfi_b32 v73, v233, 0, v65
    v_bfi_b32 v74, v234, 0, v66
    v_bfi_b32 v75, v235, 0, v67
    v_bfi_b32 v76, v236, 0, v68
    v_bfi_b32 v77, v237, 0, v69
    v_bfi_b32 v78, v238, 0, v70
    v_bfi_b32 v79, v239, 0, v71
    v_and_b32 v64, v232, v64
    v_and_b32 v65, v233, v65
    v_and_b32 v66, v234, v66
    v_and_b32 v67, v235, v67
    v_and_b32 v68, v236, v68
    v_and_b32 v69, v237, v69
    v_and_b32 v70, v238, v70
    v_and_b32 v71, v239, v71
    s_waitcnt lgkmcnt(0)
    v_exp_f32 v80, v80
    v_mfma_f32_32x32x16_bf16 v[200:215], v[216:219], v[64:67], 0
    v_exp_f32 v81, v81
    v_exp_f32 v82, v82
    v_exp_f32 v83, v83
    v_mfma_f32_32x32x16_bf16 v[200:215], v[220:223], v[68:71], v[200:215]
    v_exp_f32 v84, v84
    v_exp_f32 v85, v85
    v_exp_f32 v86, v86
    v_mfma_f32_32x32x16_bf16 v[200:215], v[224:227], v[72:75], v[200:215]
    s_mov_b64 exec, s[28:29]
    ds_read_b128 v[216:219], v246 offset:7168
    ds_read_b128 v[220:223], v246 offset:7680
    s_mov_b64 exec, -1
    v_exp_f32 v87, v87
    v_exp_f32 v88, v88
    v_exp_f32 v89, v89
    v_mfma_f32_32x32x16_bf16 v[200:215], v[228:231], v[76:79], v[200:215]
    v_exp_f32 v90, v90
    v_exp_f32 v91, v91
    v_exp_f32 v92, v92
    v_mfma_f32_32x32x16_bf16 v[112:127], v[164:167], v[28:31], 0
    v_exp_f32 v93, v93
    v_exp_f32 v94, v94
    v_exp_f32 v95, v95
    v_cvt_pk_bf16_f32 v80, v80, v81
    v_cvt_pk_bf16_f32 v81, v82, v83
    v_cvt_pk_bf16_f32 v82, v84, v85
    v_cvt_pk_bf16_f32 v83, v86, v87
    v_cvt_pk_bf16_f32 v84, v88, v89
    v_cvt_pk_bf16_f32 v85, v90, v91
    v_cvt_pk_bf16_f32 v86, v92, v93
    v_cvt_pk_bf16_f32 v87, v94, v95
    s_waitcnt lgkmcnt(0)
    s_cmp_lt_u32 s41, 4
    s_cbranch_scc1 L_hg17f
    s_setprio 1
    s_waitcnt vmcnt(0)
    v_mov_b32 v4, 149376
    s_mov_b64 exec, 1
    ds_add_u32 v4, v243 offset:20
    s_mov_b64 exec, -1
    v_mov_b32 v4, 149376
    s_mov_b32 s3, 262144
L_sp8:
    s_sleep 1
    s_sub_u32 s3, s3, 1
    ds_read_b32 v5, v4 offset:24
    s_waitcnt lgkmcnt(0)
    v_cmp_gt_u32 vcc, 1, v5
    s_cselect_b64 vcc, 0, vcc
    s_cbranch_vccnz L_sp8
    s_mov_b32 m0, s98
    s_add_u32 s24, s6, 63488
    buffer_load_dwordx4 v248, s[52:55], s6 offen offset:0  lds
    buffer_load_dwordx4 v248, s[52:55], s6 offen offset:1024  lds
    s_mov_b64 exec, 0xffff
    buffer_load_dwordx4 v248, s[52:55], s24 offen offset:2048  lds
    s_mov_b64 exec, -1
L_hg17f:
    s_mov_b64 exec, s[28:29]
    ds_read_b128 v[224:227], v246 offset:6144
    ds_read_b128 v[228:231], v246 offset:6656
    s_mov_b64 exec, -1
    v_exp_f32 v96, v96
    v_mfma_f32_32x32x16_bf16 v[200:215], v[216:219], v[80:83], v[200:215]
    v_exp_f32 v97, v97
    v_exp_f32 v98, v98
    v_exp_f32 v99, v99
    v_exp_f32 v100, v100
    v_exp_f32 v101, v101
    v_mfma_f32_32x32x16_bf16 v[200:215], v[220:223], v[84:87], v[200:215]
    v_exp_f32 v102, v102
    v_exp_f32 v103, v103
    v_exp_f32 v104, v104
    v_exp_f32 v105, v105
    v_exp_f32 v106, v106
    v_mfma_f32_32x32x16_bf16 v[80:95], v[160:163], v[28:31], 0
    v_exp_f32 v107, v107
    v_exp_f32 v108, v108
    v_exp_f32 v109, v109
    v_exp_f32 v110, v110
    v_exp_f32 v111, v111
    v_cvt_pk_bf16_f32 v96, v96, v97
    v_cvt_pk_bf16_f32 v97, v98, v99
    v_cvt_pk_bf16_f32 v98, v100, v101
    v_cvt_pk_bf16_f32 v99, v102, v103
    v_cvt_pk_bf16_f32 v100, v104, v105
    v_cvt_pk_bf16_f32 v101, v106, v107
    v_cvt_pk_bf16_f32 v102, v108, v109
    v_cvt_pk_bf16_f32 v103, v110, v111
    s_waitcnt lgkmcnt(0)
    s_cmp_lg_u32 s20, 1
    s_cbranch_scc1 L_hg016f
    s_mov_b64 exec, 3
    v_lshlrev_b32 v5, 11, v1
    v_add_u32 v5, 65536, v5
    buffer_load_dword v250, v5, s[52:55], s6 offen offset:256 sc1
    s_mov_b64 exec, -1
L_hg016f:
    s_mov_b64 exec, s[28:29]
    ds_read_b128 v[216:219], v246 offset:5120
    ds_read_b128 v[220:223], v246 offset:5632
    s_mov_b64 exec, -1
    v_exp_f32 v112, v112
    v_mfma_f32_32x32x16_bf16 v[200:215], v[224:227], v[96:99], v[200:215]
    v_exp_f32 v113, v113
    v_exp_f32 v114, v114
    v_exp_f32 v115, v115
    v_exp_f32 v116, v116
    v_exp_f32 v117, v117
    v_mfma_f32_32x32x16_bf16 v[200:215], v[228:231], v[100:103], v[200:215]
    v_exp_f32 v118, v118
    v_exp_f32 v119, v119
    v_exp_f32 v120, v120
    v_exp_f32 v121, v121
    v_exp_f32 v122, v122
    v_mfma_f32_32x32x16_bf16 v[96:111], v[156:159], v[28:31], 0
    v_exp_f32 v123, v123
    v_exp_f32 v124, v124
    v_exp_f32 v125, v125
    v_exp_f32 v126, v126
    v_exp_f32 v127, v127
    v_cvt_pk_bf16_f32 v112, v112, v113
    v_cvt_pk_bf16_f32 v113, v114, v115
    v_cvt_pk_bf16_f32 v114, v116, v117
    v_cvt_pk_bf16_f32 v115, v118, v119
    v_cvt_pk_bf16_f32 v116, v120, v121
    v_cvt_pk_bf16_f32 v117, v122, v123
    v_cvt_pk_bf16_f32 v118, v124, v125
    v_cvt_pk_bf16_f32 v119, v126, v127
    s_waitcnt lgkmcnt(0)
    s_cmp_lt_u32 s41, 4
    s_cbranch_scc1 L_hg15f
    v_xor_b32 v36, 16, v242
    v_xor_b32 v40, 32, v242
    v_xor_b32 v44, 48, v242
    s_waitcnt vmcnt(0)
    ds_read_b128 v[32:35], v242
    ds_read_b128 v[36:39], v36
    ds_read_b128 v[40:43], v40
    ds_read_b128 v[44:47], v44
L_hg15f:
    s_mov_b64 exec, s[28:29]
    ds_read_b128 v[224:227], v246 offset:4096
    ds_read_b128 v[228:231], v246 offset:4608
    s_mov_b64 exec, -1
    v_exp_f32 v80, v80
    v_mfma_f32_32x32x16_bf16 v[200:215], v[216:219], v[112:115], v[200:215]
    v_exp_f32 v81, v81
    v_exp_f32 v82, v82
    v_exp_f32 v83, v83
    v_exp_f32 v84, v84
    v_exp_f32 v85, v85
    v_mfma_f32_32x32x16_bf16 v[200:215], v[220:223], v[116:119], v[200:215]
    v_exp_f32 v86, v86
    v_exp_f32 v87, v87
    v_exp_f32 v88, v88
    v_exp_f32 v89, v89
    v_exp_f32 v90, v90
    v_mfma_f32_32x32x16_bf16 v[112:127], v[152:155], v[28:31], 0
    v_exp_f32 v91, v91
    v_exp_f32 v92, v92
    v_exp_f32 v93, v93
    v_exp_f32 v94, v94
    v_exp_f32 v95, v95
    v_cvt_pk_bf16_f32 v80, v80, v81
    v_cvt_pk_bf16_f32 v81, v82, v83
    v_cvt_pk_bf16_f32 v82, v84, v85
    v_cvt_pk_bf16_f32 v83, v86, v87
    v_cvt_pk_bf16_f32 v84, v88, v89
    v_cvt_pk_bf16_f32 v85, v90, v91
    v_cvt_pk_bf16_f32 v86, v92, v93
    v_cvt_pk_bf16_f32 v87, v94, v95
    s_waitcnt lgkmcnt(0)
    s_cmp_lg_u32 s20, 0
    s_cbranch_scc1 L_hg004f
    s_mov_b64 exec, 3
    v_lshlrev_b32 v5, 11, v1
    v_add_u32 v5, 65536, v5
    buffer_load_dword v250, v5, s[52:55], s6 offen offset:256 sc1
    s_mov_b64 exec, -1
L_hg004f:
    s_cmp_lt_u32 s41, 4
    s_cbranch_scc1 L_hg14f
    v_cvt_pk_bf16_f32 v32, v32, v33
    v_cvt_pk_bf16_f32 v33, v34, v35
    v_cvt_pk_bf16_f32 v34, v36, v37
    v_cvt_pk_bf16_f32 v35, v38, v39
    v_cvt_pk_bf16_f32 v36, v40, v41
    v_cvt_pk_bf16_f32 v37, v42, v43
    v_cvt_pk_bf16_f32 v38, v44, v45
    v_cvt_pk_bf16_f32 v39, v46, v47
    v_mfma_f32_32x32x16_bf16 v[64:79], v[32:35], v[48:51], 0
    s_nop 0
    v_mfma_f32_32x32x16_bf16 v[180:195], v[36:39], v[52:55], 0
L_hg14f:
    s_mov_b64 exec, s[28:29]
    ds_read_b128 v[216:219], v246 offset:3072
    ds_read_b128 v[220:223], v246 offset:3584
    s_mov_b64 exec, -1
    v_exp_f32 v96, v96
    v_mfma_f32_32x32x16_bf16 v[200:215], v[224:227], v[80:83], v[200:215]
    v_exp_f32 v97, v97
    v_exp_f32 v98, v98
    v_exp_f32 v99, v99
    v_exp_f32 v100, v100
    v_exp_f32 v101, v101
    v_mfma_f32_32x32x16_bf16 v[200:215], v[228:231], v[84:87], v[200:215]
    v_exp_f32 v102, v102
    v_exp_f32 v103, v103
    v_exp_f32 v104, v104
    v_exp_f32 v105, v105
    v_exp_f32 v106, v106
    v_mfma_f32_32x32x16_bf16 v[80:95], v[148:151], v[28:31], 0
    v_exp_f32 v107, v107
    v_exp_f32 v108, v108
    v_exp_f32 v109, v109
    v_exp_f32 v110, v110
    v_exp_f32 v111, v111
    v_cvt_pk_bf16_f32 v96, v96, v97
    v_cvt_pk_bf16_f32 v97, v98, v99
    v_cvt_pk_bf16_f32 v98, v100, v101
    v_cvt_pk_bf16_f32 v99, v102, v103
    v_cvt_pk_bf16_f32 v100, v104, v105
    v_cvt_pk_bf16_f32 v101, v106, v107
    v_cvt_pk_bf16_f32 v102, v108, v109
    v_cvt_pk_bf16_f32 v103, v110, v111
    s_waitcnt lgkmcnt(0)
    s_cmp_lg_u32 s20, 1
    s_cbranch_scc1 L_hg013f
    s_mov_b64 exec, 3
    s_waitcnt vmcnt(0)
    v_cmp_ne_u32 vcc, 16, v250
    s_cbranch_vccnz L_ps9
L_pd9:
    v_mov_b32 v4, 149376
    s_mov_b64 exec, 1
L_chain7:
L_pad7:
    s_cbranch_execz L_pad11
    ds_add_u32 v4, v243 offset:24
    s_mov_b64 exec, -1
    s_setprio 2
    s_mov_b32 m0, s98
    s_add_u32 s24, s6, 63488
    buffer_load_dwordx4 v248, s[52:55], s6 offen offset:0  lds
    buffer_load_dwordx4 v248, s[52:55], s6 offen offset:1024  lds
    s_mov_b64 exec, 0xffff
    buffer_load_dwordx4 v248, s[52:55], s24 offen offset:2048  lds
    s_mov_b64 exec, -1
L_hg013f:
    s_cmp_lt_u32 s41, 4
    s_cbranch_scc1 L_hg13f
    v_mov_b32 v6, 0x358637bd
    v_rcp_f32 v4, v73
    v_rcp_f32 v5, v189
    v_fmac_f32 v6, v72, v4
    v_fmac_f32 v6, v188, v5
    v_rcp_f32 v6, v6
    s_nop 0
    v_mul_f32 v4, v4, v6
    v_mul_f32 v5, v5, v6
    v_mul_f32 v64, v64, v4
    v_mul_f32 v65, v65, v4
    v_mul_f32 v66, v66, v4
    v_mul_f32 v67, v67, v4
    v_mul_f32 v68, v68, v4
    v_mul_f32 v69, v69, v4
    v_mul_f32 v70, v70, v4
    v_mul_f32 v71, v71, v4
    v_fmac_f32 v64, v180, v5
    v_fmac_f32 v65, v181, v5
    v_fmac_f32 v66, v182, v5
    v_fmac_f32 v67, v183, v5
    v_fmac_f32 v68, v184, v5
    v_fmac_f32 v69, v185, v5
    v_fmac_f32 v70, v186, v5
    v_fmac_f32 v71, v187, v5
    v_cvt_pk_bf16_f32 v20, v64, v65
    v_cvt_pk_bf16_f32 v21, v66, v67
    v_cvt_pk_bf16_f32 v22, v68, v69
    v_cvt_pk_bf16_f32 v23, v70, v71
    buffer_store_dwordx4 v[20:23], v8, s[52:55], s7 offen sc1
L_hg13f:
    s_mov_b64 exec, s[28:29]
    ds_read_b128 v[224:227], v246 offset:2048
    ds_read_b128 v[228:231], v246 offset:2560
    s_mov_b64 exec, -1
    v_exp_f32 v112, v112
    v_mfma_f32_32x32x16_bf16 v[200:215], v[216:219], v[96:99], v[200:215]
    v_exp_f32 v113, v113
    v_exp_f32 v114, v114
    v_exp_f32 v115, v115
    v_exp_f32 v116, v116
    v_exp_f32 v117, v117
    v_exp_f32 v118, v118
    v_exp_f32 v119, v119
    v_exp_f32 v120, v120
    v_mfma_f32_32x32x16_bf16 v[200:215], v[220:223], v[100:103], v[200:215]
    v_exp_f32 v121, v121
    v_exp_f32 v122, v122
    v_exp_f32 v123, v123
    v_exp_f32 v124, v124
    v_exp_f32 v125, v125
    v_exp_f32 v126, v126
    v_exp_f32 v127, v127
    v_cvt_pk_bf16_f32 v112, v112, v113
    v_cvt_pk_bf16_f32 v113, v114, v115
    v_cvt_pk_bf16_f32 v114, v116, v117
    v_cvt_pk_bf16_f32 v115, v118, v119
    v_cvt_pk_bf16_f32 v116, v120, v121
    v_cvt_pk_bf16_f32 v117, v122, v123
    v_cvt_pk_bf16_f32 v118, v124, v125
    v_cvt_pk_bf16_f32 v119, v126, v127
    s_waitcnt lgkmcnt(0)
    s_cmp_lg_u32 s20, 0
    s_cbranch_scc1 L_hg002f
    s_mov_b64 exec, 3
    s_waitcnt vmcnt(0)
    v_cmp_ne_u32 vcc, 16, v250
    s_cbranch_vccnz L_ps10
L_pd10:
    v_mov_b32 v4, 149376
    s_mov_b64 exec, 1
    ds_add_u32 v4, v243 offset:24
    s_mov_b64 exec, -1
    s_setprio 2
    s_mov_b32 m0, s98
    s_add_u32 s24, s6, 63488
    buffer_load_dwordx4 v248, s[52:55], s6 offen offset:0  lds
    buffer_load_dwordx4 v248, s[52:55], s6 offen offset:1024  lds
    s_mov_b64 exec, 0xffff
    buffer_load_dwordx4 v248, s[52:55], s24 offen offset:2048  lds
    s_mov_b64 exec, -1
L_hg002f:
    s_mov_b64 exec, s[28:29]
    ds_read_b128 v[216:219], v246 offset:1024
    ds_read_b128 v[220:223], v246 offset:1536
    s_mov_b64 exec, -1
    v_exp_f32 v80, v80
    v_mfma_f32_32x32x16_bf16 v[200:215], v[224:227], v[112:115], v[200:215]
    v_exp_f32 v81, v81
    v_exp_f32 v82, v82
    v_exp_f32 v83, v83
    v_exp_f32 v84, v84
    v_exp_f32 v85, v85
    v_exp_f32 v86, v86
    v_exp_f32 v87, v87
    v_exp_f32 v88, v88
    v_mfma_f32_32x32x16_bf16 v[200:215], v[228:231], v[116:119], v[200:215]
    v_exp_f32 v89, v89
    v_exp_f32 v90, v90
    v_exp_f32 v91, v91
    v_exp_f32 v92, v92
    v_exp_f32 v93, v93
    v_exp_f32 v94, v94
    v_exp_f32 v95, v95
    v_cvt_pk_bf16_f32 v80, v80, v81
    v_cvt_pk_bf16_f32 v81, v82, v83
    v_cvt_pk_bf16_f32 v82, v84, v85
    v_cvt_pk_bf16_f32 v83, v86, v87
    v_cvt_pk_bf16_f32 v84, v88, v89
    v_cvt_pk_bf16_f32 v85, v90, v91
    v_cvt_pk_bf16_f32 v86, v92, v93
    v_cvt_pk_bf16_f32 v87, v94, v95
    s_waitcnt lgkmcnt(1)
    v_mfma_f32_32x32x16_bf16 v[200:215], v[216:219], v[80:83], v[200:215]
    s_waitcnt lgkmcnt(0)
    v_mfma_f32_32x32x16_bf16 v[200:215], v[220:223], v[84:87], v[200:215]
L_bdone:
    s_add_u32 s24, s7, 2105344
    s_add_u32 s27, s8, 1024
    s_nop 9
    v_pk_mul_f32 v[2:3], v[200:201], 0
    v_pk_fma_f32 v[2:3], v[202:203], 0, v[2:3]
    v_pk_fma_f32 v[2:3], v[204:205], 0, v[2:3]
    v_pk_fma_f32 v[2:3], v[206:207], 0, v[2:3]
    v_add_f32 v2, v2, v3
    v_add_f32 v2, v2, v208
    v_subrev_u32 v2, 0x21800000, v2
    v_cmp_lt_u32 vcc, 0x3c000000, v2
    s_cbranch_vccnz L_bexact
L_bdone2:
    v_rcp_f32 v4, v208
    s_nop 0
    v_pk_mul_f32 v[200:201], v[200:201], v[4:5] op_sel_hi:[1,0]
    v_pk_mul_f32 v[202:203], v[202:203], v[4:5] op_sel_hi:[1,0]
    v_pk_mul_f32 v[204:205], v[204:205], v[4:5] op_sel_hi:[1,0]
    v_pk_mul_f32 v[206:207], v[206:207], v[4:5] op_sel_hi:[1,0]
    v_cvt_pk_bf16_f32 v16, v200, v201
    v_cvt_pk_bf16_f32 v17, v202, v203
    v_cvt_pk_bf16_f32 v18, v204, v205
    v_cvt_pk_bf16_f32 v19, v206, v207
    buffer_store_dwordx4 v[16:19], v8, s[52:55], s24 offen sc1
    s_cmp_ge_u32 s41, 4
    s_cbranch_scc1 L_nord
    v_mov_b32 v4, 149376
    s_mov_b32 s3, 262144
L_sp11:
    s_sub_u32 s3, s3, 1
    ds_read_b32 v5, v4 offset:16
    s_waitcnt lgkmcnt(0)
    v_cmp_gt_u32 vcc, 4, v5
    s_cselect_b64 vcc, 0, vcc
    s_cbranch_vccnz L_sp11
    ds_read_b128 v[48:51], v9 offset:4096
    ds_read_b128 v[52:55], v9 offset:5120
    v_xor_b32 v36, 16, v242
    v_xor_b32 v40, 32, v242
    v_xor_b32 v44, 48, v242
    s_waitcnt vmcnt(1)
    ds_read_b128 v[32:35], v242
    ds_read_b128 v[36:39], v36
    ds_read_b128 v[40:43], v40
    ds_read_b128 v[44:47], v44
    s_waitcnt lgkmcnt(0)
    v_cvt_pk_bf16_f32 v32, v32, v33
    v_cvt_pk_bf16_f32 v33, v34, v35
    v_cvt_pk_bf16_f32 v34, v36, v37
    v_cvt_pk_bf16_f32 v35, v38, v39
    v_cvt_pk_bf16_f32 v36, v40, v41
    v_cvt_pk_bf16_f32 v37, v42, v43
    v_cvt_pk_bf16_f32 v38, v44, v45
    v_cvt_pk_bf16_f32 v39, v46, v47
    v_mfma_f32_32x32x16_bf16 v[64:79], v[32:35], v[48:51], 0
    s_nop 0
    v_mfma_f32_32x32x16_bf16 v[180:195], v[36:39], v[52:55], 0
    v_mov_b32 v6, 0x358637bd
    s_nop 8
    v_rcp_f32 v4, v73
    s_nop 0
    v_rcp_f32 v5, v189
    v_fmac_f32 v6, v72, v4
    v_fmac_f32 v6, v188, v5
    v_rcp_f32 v6, v6
    s_nop 0
    v_mul_f32 v4, v4, v6
    v_mul_f32 v5, v5, v6
    v_mul_f32 v64, v64, v4
    v_mul_f32 v65, v65, v4
    v_mul_f32 v66, v66, v4
    v_mul_f32 v67, v67, v4
    v_mul_f32 v68, v68, v4
    v_mul_f32 v69, v69, v4
    v_mul_f32 v70, v70, v4
    v_mul_f32 v71, v71, v4
    v_fmac_f32 v64, v180, v5
    v_fmac_f32 v65, v181, v5
    v_fmac_f32 v66, v182, v5
    v_fmac_f32 v67, v183, v5
    v_fmac_f32 v68, v184, v5
    v_fmac_f32 v69, v185, v5
    v_fmac_f32 v70, v186, v5
    v_fmac_f32 v71, v187, v5
    v_cvt_pk_bf16_f32 v20, v64, v65
    v_cvt_pk_bf16_f32 v21, v66, v67
    v_cvt_pk_bf16_f32 v22, v68, v69
    v_cvt_pk_bf16_f32 v23, v70, v71
    buffer_store_dwordx4 v[20:23], v8, s[52:55], s7 offen sc1
L_nord:
    v_bfe_u32 v6, v1, 2, 2
    v_lshl_add_u32 v6, v11, 2, v6
    v_lshlrev_b32 v6, 7, v6
    v_and_b32 v7, 1, v1
    v_lshl_add_u32 v6, v7, 5, v6
    v_bfe_u32 v7, v1, 1, 1
    v_lshl_add_u32 v6, v7, 3, v6
    v_and_b32 v7, 16, v1
    v_add_u32 v6, v6, v7
    s_lshr_b32 s24, s41, 2
    s_lshl_b32 s24, s24, 11
    v_bfe_u32 v7, v1, 3, 1
    v_lshl_add_u32 v6, v7, 6, v6
    v_add_u32 v2, s24, v6
    v_xor_b32 v3, 64, v2
    s_mov_b32 s25, 0
    s_lshl_b32 s24, s25, 12
    v_add_u32 v2, s24, v2
    v_add_u32 v3, s24, v3
    v_xor_b32 v6, 4096, v2
    v_xor_b32 v7, 4096, v3
    s_lshl_b32 s24, s25, 14
    s_sub_u32 s31, s13, s24
    s_add_u32 s13, s13, s24
L_nosp:
    v_mov_b32 v12, 149376
    s_mov_b32 s3, 262144
L_sp12:
    s_sub_u32 s3, s3, 1
    ds_read_b32 v13, v12 offset:20
    s_waitcnt lgkmcnt(0)
    v_cmp_gt_u32 vcc, 4, v13
    s_cselect_b64 vcc, 0, vcc
    s_cbranch_vccnz L_sp12
    ds_read_b64_tr_b16 v[80:81], v2 offset:0
    ds_read_b64_tr_b16 v[82:83], v2 offset:1024
    ds_read_b64_tr_b16 v[84:85], v3 offset:0
    ds_read_b64_tr_b16 v[86:87], v3 offset:1024
    ds_read_b64_tr_b16 v[88:89], v2 offset:8192
    ds_read_b64_tr_b16 v[90:91], v2 offset:9216
    ds_read_b64_tr_b16 v[92:93], v3 offset:8192
    ds_read_b64_tr_b16 v[94:95], v3 offset:9216
    ds_read_b64_tr_b16 v[96:97], v2 offset:16384
    ds_read_b64_tr_b16 v[98:99], v2 offset:17408
    ds_read_b64_tr_b16 v[100:101], v3 offset:16384
    ds_read_b64_tr_b16 v[102:103], v3 offset:17408
    s_add_u32 s26, s13, 4096
    s_lshr_b32 s24, s41, 2
    s_lshl_b32 s3, s24, 3
    v_lshlrev_b32 v15, s3, v243
    v_lshlrev_b32 v13, 10, v1
    s_waitcnt vmcnt(0)
    buffer_load_dword v250, v244, s[52:55], s12 offen sc1
    s_mov_b64 exec, 3
    buffer_atomic_add v243, v13, s[52:55], s8 offen
    s_mov_b64 exec, 1
    ds_add_u32 v12, v15 offset:8
    s_mov_b64 exec, -1
    s_setprio 0
    ds_read_b64_tr_b16 v[104:105], v2 offset:24576
    ds_read_b64_tr_b16 v[106:107], v2 offset:25600
    ds_read_b64_tr_b16 v[108:109], v3 offset:24576
    ds_read_b64_tr_b16 v[110:111], v3 offset:25600
    ds_read_b64_tr_b16 v[112:113], v2 offset:32768
    ds_read_b64_tr_b16 v[114:115], v2 offset:33792
    ds_read_b64_tr_b16 v[116:117], v3 offset:32768
    ds_read_b64_tr_b16 v[118:119], v3 offset:33792
    ds_read_b64_tr_b16 v[120:121], v2 offset:40960
    ds_read_b64_tr_b16 v[122:123], v2 offset:41984
    ds_read_b64_tr_b16 v[124:125], v3 offset:40960
    ds_read_b64_tr_b16 v[126:127], v3 offset:41984
    ds_read_b64_tr_b16 v[128:129], v2 offset:49152
    ds_read_b64_tr_b16 v[130:131], v2 offset:50176
    ds_read_b64_tr_b16 v[132:133], v3 offset:49152
    ds_read_b64_tr_b16 v[134:135], v3 offset:50176
    ds_read_b64_tr_b16 v[136:137], v2 offset:57344
    ds_read_b64_tr_b16 v[138:139], v2 offset:58368
    ds_read_b64_tr_b16 v[140:141], v3 offset:57344
    ds_read_b64_tr_b16 v[142:143], v3 offset:58368
    ds_read_b64_tr_b16 v[144:145], v6 offset:0
    ds_read_b64_tr_b16 v[146:147], v6 offset:1024
    ds_read_b64_tr_b16 v[148:149], v7 offset:0
    ds_read_b64_tr_b16 v[150:151], v7 offset:1024
    ds_read_b64_tr_b16 v[152:153], v6 offset:8192
    ds_read_b64_tr_b16 v[154:155], v6 offset:9216
    ds_read_b64_tr_b16 v[156:157], v7 offset:8192
    ds_read_b64_tr_b16 v[158:159], v7 offset:9216
    ds_read_b64_tr_b16 v[160:161], v6 offset:16384
    ds_read_b64_tr_b16 v[162:163], v6 offset:17408
    ds_read_b64_tr_b16 v[164:165], v7 offset:16384
    ds_read_b64_tr_b16 v[166:167], v7 offset:17408
    ds_read_b64_tr_b16 v[168:169], v6 offset:24576
    ds_read_b64_tr_b16 v[170:171], v6 offset:25600
    ds_read_b64_tr_b16 v[172:173], v7 offset:24576
    ds_read_b64_tr_b16 v[174:175], v7 offset:25600
    ds_read_b64_tr_b16 v[176:177], v6 offset:32768
    ds_read_b64_tr_b16 v[178:179], v6 offset:33792
    ds_read_b64_tr_b16 v[180:181], v7 offset:32768
    ds_read_b64_tr_b16 v[182:183], v7 offset:33792
    ds_read_b64_tr_b16 v[184:185], v6 offset:40960
    ds_read_b64_tr_b16 v[186:187], v6 offset:41984
    ds_read_b64_tr_b16 v[188:189], v7 offset:40960
    ds_read_b64_tr_b16 v[190:191], v7 offset:41984
    ds_read_b64_tr_b16 v[192:193], v6 offset:49152
    ds_read_b64_tr_b16 v[194:195], v6 offset:50176
    ds_read_b64_tr_b16 v[196:197], v7 offset:49152
    ds_read_b64_tr_b16 v[198:199], v7 offset:50176
    ds_read_b64_tr_b16 v[200:201], v6 offset:57344
    ds_read_b64_tr_b16 v[202:203], v6 offset:58368
    ds_read_b64_tr_b16 v[204:205], v7 offset:57344
    ds_read_b64_tr_b16 v[206:207], v7 offset:58368
    v_and_b32 v9, 15, v1
    v_lshlrev_b32 v9, 11, v9
    v_and_b32 v14, 48, v1
    v_add_u32 v9, v9, v14
    s_and_b32 s24, s41, 3
    s_lshl_b32 s25, s24, 13
    s_add_u32 s25, s25, 114688
    v_add_u32 v4, s25, v8
    s_lshl_b32 s24, s24, 2
    s_add_u32 s24, s24, 149424
    v_mov_b32 v5, s24
    v_and_b32 v14, 7, v1
    v_lshlrev_b32 v9, 1, v11
    v_xor_b32 v9, v9, v14
    v_lshl_add_u32 v9, v10, 3, v9
    v_lshl_add_u32 v245, v9, 4, s25
    v_add_u32 v249, s25, v248
    v_xor_b32 v246, 16, v245
    v_xor_b32 v247, 64, v245
    v_xor_b32 v248, 80, v245
    v_lshrrev_b32 v9, 3, v1
    v_lshlrev_b32 v9, 11, v9
    v_lshl_add_u32 v9, v14, 4, v9
    s_add_u32 s28, s14, 16384
    s_add_u32 s29, s14, 49152
    s_mov_b32 s56, s18
    s_mov_b32 s57, s19
    s_mov_b32 s58, 0x400000
    s_mov_b32 s59, 0x20000
    s_add_u32 s24, s31, 16384
    s_add_u32 s25, s31, 20480
    s_add_u32 s27, s14, 32768
    s_waitcnt vmcnt(1)
    v_cmp_ne_u32 vcc, 16, v250
    s_cbranch_vccz L_pd13
    s_mov_b32 s3, 65536
L_pl13:
    s_sleep 2
    buffer_load_dword v250, v244, s[52:55], s12 offen sc1
    s_sub_u32 s3, s3, 1
    s_waitcnt vmcnt(0)
    v_cmp_ne_u32 vcc, 16, v250
    s_cselect_b64 vcc, 0, vcc
    s_cbranch_vccnz L_pl13
L_pd13:
    s_cmp_ge_u32 s41, 4
    s_cbranch_scc1 L_noatt
    v_mov_b32 v12, 149376
    s_mov_b32 s3, 262144
L_sp14:
    s_sleep 1
    s_sub_u32 s3, s3, 1
    ds_read_b32 v13, v12 offset:8
    s_waitcnt lgkmcnt(0)
    v_cmp_gt_u32 vcc, 1024, v13
    s_cselect_b64 vcc, 0, vcc
    s_cbranch_vccnz L_sp14
L_noatt:
    buffer_load_dwordx4 v[16:19], v8, s[52:55], s13 offen offset:0 sc1
    buffer_load_dwordx4 v[20:23], v8, s[52:55], s13 offen offset:1024 sc1
    buffer_load_dwordx4 v[24:27], v8, s[52:55], s13 offen offset:2048 sc1
    buffer_load_dwordx4 v[28:31], v8, s[52:55], s13 offen offset:3072 sc1
    buffer_load_dwordx4 v[32:35], v8, s[52:55], s26 offen offset:0 sc1
    buffer_load_dwordx4 v[36:39], v8, s[52:55], s26 offen offset:1024 sc1
    buffer_load_dwordx4 v[40:43], v8, s[52:55], s26 offen offset:2048 sc1
    buffer_load_dwordx4 v[44:47], v8, s[52:55], s26 offen offset:3072 sc1
L_late8:
    buffer_load_dwordx4 v[48:51], v8, s[52:55], s24 offen offset:0 sc1
    buffer_load_dwordx4 v[52:55], v8, s[52:55], s24 offen offset:1024 sc1
    buffer_load_dwordx4 v[56:59], v8, s[52:55], s24 offen offset:2048 sc1
    buffer_load_dwordx4 v[60:63], v8, s[52:55], s24 offen offset:3072 sc1
    buffer_load_dwordx4 v[64:67], v8, s[52:55], s25 offen offset:0 sc1
    buffer_load_dwordx4 v[68:71], v8, s[52:55], s25 offen offset:1024 sc1
    buffer_load_dwordx4 v[72:75], v8, s[52:55], s25 offen offset:2048 sc1
    buffer_load_dwordx4 v[76:79], v8, s[52:55], s25 offen offset:3072 sc1
    s_waitcnt lgkmcnt(0)
    s_waitcnt vmcnt(15)
    v_mfma_f32_32x32x16_bf16 v[208:223], v[80:83], v[16:19], 0
    v_mfma_f32_32x32x16_bf16 v[224:239], v[84:87], v[16:19], 0
    s_waitcnt vmcnt(14)
    v_mfma_f32_32x32x16_bf16 v[208:223], v[88:91], v[20:23], v[208:223]
    v_mfma_f32_32x32x16_bf16 v[224:239], v[92:95], v[20:23], v[224:239]
    s_waitcnt vmcnt(13)
    v_mfma_f32_32x32x16_bf16 v[208:223], v[96:99], v[24:27], v[208:223]
    v_mfma_f32_32x32x16_bf16 v[224:239], v[100:103], v[24:27], v[224:239]
    s_waitcnt vmcnt(12)
    v_mfma_f32_32x32x16_bf16 v[208:223], v[104:107], v[28:31], v[208:223]
    v_mfma_f32_32x32x16_bf16 v[224:239], v[108:111], v[28:31], v[224:239]
    s_waitcnt vmcnt(11)
    v_mfma_f32_32x32x16_bf16 v[208:223], v[112:115], v[32:35], v[208:223]
    v_mfma_f32_32x32x16_bf16 v[224:239], v[116:119], v[32:35], v[224:239]
    s_waitcnt vmcnt(10)
    v_mfma_f32_32x32x16_bf16 v[208:223], v[120:123], v[36:39], v[208:223]
    v_mfma_f32_32x32x16_bf16 v[224:239], v[124:127], v[36:39], v[224:239]
    s_waitcnt vmcnt(9)
    v_mfma_f32_32x32x16_bf16 v[208:223], v[128:131], v[40:43], v[208:223]
    v_mfma_f32_32x32x16_bf16 v[224:239], v[132:135], v[40:43], v[224:239]
    s_waitcnt vmcnt(8)
    v_mfma_f32_32x32x16_bf16 v[208:223], v[136:139], v[44:47], v[208:223]
    v_mfma_f32_32x32x16_bf16 v[224:239], v[140:143], v[44:47], v[224:239]
    s_waitcnt vmcnt(7)
    v_mfma_f32_32x32x16_bf16 v[208:223], v[144:147], v[48:51], v[208:223]
    v_mfma_f32_32x32x16_bf16 v[224:239], v[148:151], v[48:51], v[224:239]
    s_waitcnt vmcnt(6)
    v_mfma_f32_32x32x16_bf16 v[208:223], v[152:155], v[52:55], v[208:223]
    s_cmp_ge_u32 s41, 4
    s_cbranch_scc1 L_fin
    v_mfma_f32_32x32x16_bf16 v[224:239], v[156:159], v[52:55], v[224:239]
    s_waitcnt vmcnt(5)
    v_mfma_f32_32x32x16_bf16 v[208:223], v[160:163], v[56:59], v[208:223]
    v_mfma_f32_32x32x16_bf16 v[224:239], v[164:167], v[56:59], v[224:239]
    s_waitcnt vmcnt(4)
    v_mfma_f32_32x32x16_bf16 v[208:223], v[168:171], v[60:63], v[208:223]
    v_mfma_f32_32x32x16_bf16 v[224:239], v[172:175], v[60:63], v[224:239]
    s_waitcnt vmcnt(3)
    v_mfma_f32_32x32x16_bf16 v[208:223], v[176:179], v[64:67], v[208:223]
    v_mfma_f32_32x32x16_bf16 v[224:239], v[180:183], v[64:67], v[224:239]
    s_waitcnt vmcnt(2)
    v_mfma_f32_32x32x16_bf16 v[208:223], v[184:187], v[68:71], v[208:223]
    v_mfma_f32_32x32x16_bf16 v[224:239], v[188:191], v[68:71], v[224:239]
    s_waitcnt vmcnt(1)
    v_mfma_f32_32x32x16_bf16 v[208:223], v[192:195], v[72:75], v[208:223]
    v_mfma_f32_32x32x16_bf16 v[224:239], v[196:199], v[72:75], v[224:239]
    s_waitcnt vmcnt(0)
    v_mfma_f32_32x32x16_bf16 v[208:223], v[200:203], v[76:79], v[208:223]
    v_mfma_f32_32x32x16_bf16 v[224:239], v[204:207], v[76:79], v[224:239]
    s_nop 10
    ds_write_b128 v4, v[208:211] offset:0
    ds_write_b128 v4, v[212:215] offset:1024
    ds_write_b128 v4, v[216:219] offset:2048
    ds_write_b128 v4, v[220:223] offset:3072
    ds_write_b128 v4, v[224:227] offset:4096
    ds_write_b128 v4, v[228:231] offset:5120
    ds_write_b128 v4, v[232:235] offset:6144
    ds_write_b128 v4, v[236:239] offset:7168
    ds_write_b32 v5, v243
    s_waitcnt lgkmcnt(0)
    s_branch L_fin2
L_fin:
    ds_read_b32 v12, v5
    ds_read_b128 v[16:19], v4 offset:0
    ds_read_b128 v[20:23], v4 offset:1024
    ds_read_b128 v[24:27], v4 offset:2048
    ds_read_b128 v[28:31], v4 offset:3072
    ds_read_b128 v[32:35], v4 offset:4096
    ds_read_b128 v[36:39], v4 offset:5120
    ds_read_b128 v[40:43], v4 offset:6144
    ds_read_b128 v[44:47], v4 offset:7168
    v_mfma_f32_32x32x16_bf16 v[224:239], v[156:159], v[52:55], v[224:239]
    s_waitcnt vmcnt(5)
    v_mfma_f32_32x32x16_bf16 v[208:223], v[160:163], v[56:59], v[208:223]
    v_mfma_f32_32x32x16_bf16 v[224:239], v[164:167], v[56:59], v[224:239]
    s_waitcnt vmcnt(4)
    v_mfma_f32_32x32x16_bf16 v[224:239], v[172:175], v[60:63], v[224:239]
    s_waitcnt lgkmcnt(0)
    v_cmp_eq_u32 vcc, 0, v12
    s_cbranch_vccnz L_prs
L_prd:
    v_add_f32 v208, v208, v16
    v_add_f32 v209, v209, v17
    v_add_f32 v210, v210, v18
    v_add_f32 v211, v211, v19
    s_waitcnt vmcnt(3)
    v_mfma_f32_32x32x16_bf16 v[224:239], v[180:183], v[64:67], v[224:239]
    v_add_f32 v212, v212, v20
    v_add_f32 v213, v213, v21
    v_add_f32 v214, v214, v22
    v_add_f32 v215, v215, v23
    v_add_f32 v216, v216, v24
    v_add_f32 v217, v217, v25
    s_waitcnt vmcnt(2)
    v_mfma_f32_32x32x16_bf16 v[224:239], v[188:191], v[68:71], v[224:239]
    v_add_f32 v218, v218, v26
    v_add_f32 v219, v219, v27
    v_add_f32 v220, v220, v28
    v_add_f32 v221, v221, v29
    v_add_f32 v222, v222, v30
    v_add_f32 v223, v223, v31
    s_nop 1
    v_mfma_f32_32x32x16_bf16 v[208:223], v[168:171], v[60:63], v[208:223]
    v_mfma_f32_32x32x16_bf16 v[208:223], v[176:179], v[64:67], v[208:223]
    v_add_f32 v224, v224, v32
    v_add_f32 v225, v225, v33
    v_add_f32 v226, v226, v34
    v_add_f32 v227, v227, v35
    v_add_f32 v228, v228, v36
    v_mfma_f32_32x32x16_bf16 v[208:223], v[184:187], v[68:71], v[208:223]
    v_add_f32 v229, v229, v37
    v_add_f32 v230, v230, v38
    v_add_f32 v231, v231, v39
    v_add_f32 v232, v232, v40
    v_add_f32 v233, v233, v41
    v_add_f32 v234, v234, v42
    s_waitcnt vmcnt(1)
    v_mfma_f32_32x32x16_bf16 v[208:223], v[192:195], v[72:75], v[208:223]
    v_add_f32 v235, v235, v43
    v_add_f32 v236, v236, v44
    v_add_f32 v237, v237, v45
    v_add_f32 v238, v238, v46
    v_add_f32 v239, v239, v47
    s_waitcnt vmcnt(0)
    v_mfma_f32_32x32x16_bf16 v[208:223], v[200:203], v[76:79], v[208:223]
    v_mfma_f32_32x32x16_bf16 v[224:239], v[196:199], v[72:75], v[224:239]
    v_mfma_f32_32x32x16_bf16 v[224:239], v[204:207], v[76:79], v[224:239]
L_pk:
    v_cvt_pk_bf16_f32 v48, v208, v209
    v_cvt_pk_bf16_f32 v49, v210, v211
    v_cvt_pk_bf16_f32 v50, v212, v213
    v_cvt_pk_bf16_f32 v51, v214, v215
    ds_write_b128 v245, v[48:51]
    v_cvt_pk_bf16_f32 v52, v216, v217
    v_cvt_pk_bf16_f32 v53, v218, v219
    v_cvt_pk_bf16_f32 v54, v220, v221
    v_cvt_pk_bf16_f32 v55, v222, v223
    ds_write_b128 v246, v[52:55]
    s_nop 1
    v_cvt_pk_bf16_f32 v56, v224, v225
    v_cvt_pk_bf16_f32 v57, v226, v227
    v_cvt_pk_bf16_f32 v58, v228, v229
    v_cvt_pk_bf16_f32 v59, v230, v231
    ds_write_b128 v247, v[56:59]
    v_cvt_pk_bf16_f32 v60, v232, v233
    v_cvt_pk_bf16_f32 v61, v234, v235
    v_cvt_pk_bf16_f32 v62, v236, v237
    v_cvt_pk_bf16_f32 v63, v238, v239
    ds_write_b128 v248, v[60:63]
    ds_read_b128 v[16:19], v249 offset:0
    ds_read_b128 v[20:23], v249 offset:1024
    ds_read_b128 v[24:27], v249 offset:2048
    ds_read_b128 v[28:31], v249 offset:3072
    s_waitcnt lgkmcnt(3)
    buffer_store_dwordx4 v[16:19], v9, s[56:59], s14 offen sc1
    s_waitcnt lgkmcnt(2)
    buffer_store_dwordx4 v[20:23], v9, s[56:59], s28 offen sc1
    s_waitcnt lgkmcnt(1)
    buffer_store_dwordx4 v[24:27], v9, s[56:59], s27 offen sc1
    s_waitcnt lgkmcnt(0)
    buffer_store_dwordx4 v[28:31], v9, s[56:59], s29 offen sc1
L_fin2:
L_end:
    s_endpgm
L_prs:
    v_mfma_f32_32x32x16_bf16 v[208:223], v[168:171], v[60:63], v[208:223]
    s_waitcnt vmcnt(3)
    v_mfma_f32_32x32x16_bf16 v[208:223], v[176:179], v[64:67], v[208:223]
    v_mfma_f32_32x32x16_bf16 v[224:239], v[180:183], v[64:67], v[224:239]
    s_waitcnt vmcnt(2)
    v_mfma_f32_32x32x16_bf16 v[208:223], v[184:187], v[68:71], v[208:223]
    v_mfma_f32_32x32x16_bf16 v[224:239], v[188:191], v[68:71], v[224:239]
    s_waitcnt vmcnt(1)
    v_mfma_f32_32x32x16_bf16 v[208:223], v[192:195], v[72:75], v[208:223]
    v_mfma_f32_32x32x16_bf16 v[224:239], v[196:199], v[72:75], v[224:239]
    s_waitcnt vmcnt(0)
    v_mfma_f32_32x32x16_bf16 v[208:223], v[200:203], v[76:79], v[208:223]
    v_mfma_f32_32x32x16_bf16 v[224:239], v[204:207], v[76:79], v[224:239]
    s_mov_b32 s3, 262144
L_prs2:
    ds_read_b32 v12, v5
    s_sub_u32 s3, s3, 1
    s_waitcnt lgkmcnt(0)
    v_cmp_eq_u32 vcc, 0, v12
    s_cselect_b64 vcc, 0, vcc
    s_cbranch_vccnz L_prs2
    ds_read_b32 v12, v5
    ds_read_b128 v[16:19], v4 offset:0
    ds_read_b128 v[20:23], v4 offset:1024
    ds_read_b128 v[24:27], v4 offset:2048
    ds_read_b128 v[28:31], v4 offset:3072
    ds_read_b128 v[32:35], v4 offset:4096
    ds_read_b128 v[36:39], v4 offset:5120
    ds_read_b128 v[40:43], v4 offset:6144
    ds_read_b128 v[44:47], v4 offset:7168
    s_waitcnt lgkmcnt(7)
    v_pk_add_f32 v[208:209], v[208:209], v[16:17]
    v_pk_add_f32 v[210:211], v[210:211], v[18:19]
    s_waitcnt lgkmcnt(6)
    v_pk_add_f32 v[212:213], v[212:213], v[20:21]
    v_pk_add_f32 v[214:215], v[214:215], v[22:23]
    s_waitcnt lgkmcnt(5)
    v_pk_add_f32 v[216:217], v[216:217], v[24:25]
    v_pk_add_f32 v[218:219], v[218:219], v[26:27]
    s_waitcnt lgkmcnt(4)
    v_pk_add_f32 v[220:221], v[220:221], v[28:29]
    v_pk_add_f32 v[222:223], v[222:223], v[30:31]
    s_waitcnt lgkmcnt(3)
    v_pk_add_f32 v[224:225], v[224:225], v[32:33]
    v_pk_add_f32 v[226:227], v[226:227], v[34:35]
    s_waitcnt lgkmcnt(2)
    v_pk_add_f32 v[228:229], v[228:229], v[36:37]
    v_pk_add_f32 v[230:231], v[230:231], v[38:39]
    s_waitcnt lgkmcnt(1)
    v_pk_add_f32 v[232:233], v[232:233], v[40:41]
    v_pk_add_f32 v[234:235], v[234:235], v[42:43]
    s_waitcnt lgkmcnt(0)
    v_pk_add_f32 v[236:237], v[236:237], v[44:45]
    v_pk_add_f32 v[238:239], v[238:239], v[46:47]
    s_branch L_pk
L_bslow:
L_pad8:
    s_cbranch_execz L_pad12
    ds_read_b128 v[176:179], v245 offset:8192
    ds_read_b128 v[144:147], v245 offset:0
    ds_read_b128 v[172:175], v245 offset:7168
    ds_read_b128 v[168:171], v245 offset:6144
    ds_read_b128 v[164:167], v245 offset:5120
    ds_read_b128 v[160:163], v245 offset:4096
    ds_read_b128 v[156:159], v245 offset:3072
    ds_read_b128 v[152:155], v245 offset:2048
    ds_read_b128 v[148:151], v245 offset:1024
    s_waitcnt lgkmcnt(8)
    v_mfma_f32_32x32x16_bf16 v[64:79], v[176:179], v[28:31], 0
    v_mov_b32 v2, 0xff800000
    v_mov_b64 v[128:129], 0
    v_mov_b64 v[130:131], 0
    v_mov_b64 v[132:133], 0
    v_mov_b64 v[134:135], 0
    v_mov_b64 v[136:137], 0
    v_mov_b64 v[138:139], 0
    v_mov_b64 v[140:141], 0
    v_mov_b64 v[142:143], 0
    s_mov_b64 exec, s[28:29]
    ds_read_b128 v[216:219], v246 offset:8192
    ds_read_b128 v[220:223], v246 offset:8704
    ds_read_b128 v[224:227], v246 offset:0
    ds_read_b128 v[228:231], v246 offset:512
    s_mov_b64 exec, -1
    v_cndmask_b32_e64 v64, v2, v64, s[64:65]
    v_cndmask_b32_e64 v65, v2, v65, s[66:67]
    v_cndmask_b32_e64 v66, v2, v66, s[68:69]
    v_cndmask_b32_e64 v67, v2, v67, s[70:71]
    v_cndmask_b32_e64 v68, v2, v68, s[72:73]
    v_cndmask_b32_e64 v69, v2, v69, s[74:75]
    v_cndmask_b32_e64 v70, v2, v70, s[76:77]
    v_cndmask_b32_e64 v71, v2, v71, s[78:79]
    v_cndmask_b32_e64 v72, v2, v72, s[80:81]
    v_cndmask_b32_e64 v73, v2, v73, s[82:83]
    v_cndmask_b32_e64 v74, v2, v74, s[84:85]
    v_cndmask_b32_e64 v75, v2, v75, s[86:87]
    v_cndmask_b32_e64 v76, v2, v76, s[88:89]
    v_cndmask_b32_e64 v77, v2, v77, s[90:91]
    v_cndmask_b32_e64 v78, v2, v78, s[92:93]
    v_cndmask_b32_e64 v79, v2, v79, s[94:95]
    v_exp_f32 v64, v64
    s_cmp_lg_u32 s4, 0
    s_cbranch_scc1 L_ni15
    s_nop 7
    v_mov_b32 v128, 0xff800000
    v_mov_b32 v129, 0xff800000
    v_mov_b32 v130, 0xff800000
    v_mov_b32 v131, 0xff800000
    v_mov_b32 v132, 0xff800000
L_pad9:
    s_cbranch_execz L_padret1
    v_mov_b32 v133, 0xff800000
    v_mov_b32 v134, 0xff800000
    v_mov_b32 v135, 0xff800000
    v_mov_b32 v136, 0xff800000
    v_mov_b32 v137, 0xff800000
    v_mov_b32 v138, 0xff800000
    v_mov_b32 v139, 0xff800000
    v_mov_b32 v140, 0xff800000
    v_mov_b32 v141, 0xff800000
    v_mov_b32 v142, 0xff800000
    v_mov_b32 v143, 0xff800000
L_ni15:
    s_nop 1
    s_waitcnt lgkmcnt(10)
    v_mfma_f32_32x32x16_bf16 v[80:95], v[172:175], v[28:31], v[128:143]
    v_exp_f32 v65, v65
    v_exp_f32 v66, v66
    v_exp_f32 v67, v67
    v_exp_f32 v68, v68
    v_exp_f32 v69, v69
    v_exp_f32 v70, v70
    v_exp_f32 v71, v71
    v_exp_f32 v72, v72
    s_cmp_lg_u32 s4, 1
    s_cbranch_scc1 L_ni16
    s_nop 7
    v_mov_b32 v128, 0xff800000
    v_mov_b32 v129, 0xff800000
    v_mov_b32 v130, 0xff800000
    v_mov_b32 v131, 0xff800000
    v_mov_b32 v132, 0xff800000
    v_mov_b32 v133, 0xff800000
    v_mov_b32 v134, 0xff800000
    v_mov_b32 v135, 0xff800000
    v_mov_b32 v136, 0xff800000
    v_mov_b32 v137, 0xff800000
    v_mov_b32 v138, 0xff800000
    v_mov_b32 v139, 0xff800000
    v_mov_b32 v140, 0xff800000
    v_mov_b32 v141, 0xff800000
    v_mov_b32 v142, 0xff800000
    v_mov_b32 v143, 0xff800000
L_ni16:
    s_nop 1
    s_waitcnt lgkmcnt(9)
    v_mfma_f32_32x32x16_bf16 v[96:111], v[168:171], v[28:31], v[128:143]
    v_exp_f32 v73, v73
    v_exp_f32 v74, v74
    v_exp_f32 v75, v75
    v_exp_f32 v76, v76
    v_exp_f32 v77, v77
    v_exp_f32 v78, v78
    v_exp_f32 v79, v79
    v_cvt_pk_bf16_f32 v64, v64, v65
    v_cvt_pk_bf16_f32 v65, v66, v67
    v_cvt_pk_bf16_f32 v66, v68, v69
    v_cvt_pk_bf16_f32 v67, v70, v71
    v_cvt_pk_bf16_f32 v68, v72, v73
    v_cvt_pk_bf16_f32 v69, v74, v75
    v_cvt_pk_bf16_f32 v70, v76, v77
    v_cvt_pk_bf16_f32 v71, v78, v79
    v_bfi_b32 v72, v232, 0, v64
    v_bfi_b32 v73, v233, 0, v65
    v_bfi_b32 v74, v234, 0, v66
    v_bfi_b32 v75, v235, 0, v67
    v_bfi_b32 v76, v236, 0, v68
    v_bfi_b32 v77, v237, 0, v69
    v_bfi_b32 v78, v238, 0, v70
    v_bfi_b32 v79, v239, 0, v71
    v_and_b32 v64, v232, v64
    v_and_b32 v65, v233, v65
    v_and_b32 v66, v234, v66
    v_and_b32 v67, v235, v67
    v_and_b32 v68, v236, v68
    v_and_b32 v69, v237, v69
    v_and_b32 v70, v238, v70
    v_and_b32 v71, v239, v71
    s_waitcnt lgkmcnt(0)
    v_exp_f32 v80, v80
    v_mfma_f32_32x32x16_bf16 v[200:215], v[216:219], v[64:67], 0
    v_exp_f32 v81, v81
    v_exp_f32 v82, v82
    v_exp_f32 v83, v83
    v_mfma_f32_32x32x16_bf16 v[200:215], v[220:223], v[68:71], v[200:215]
    v_exp_f32 v84, v84
    v_exp_f32 v85, v85
    v_exp_f32 v86, v86
    v_mfma_f32_32x32x16_bf16 v[200:215], v[224:227], v[72:75], v[200:215]
    s_mov_b64 exec, s[28:29]
    ds_read_b128 v[216:219], v246 offset:7168
    ds_read_b128 v[220:223], v246 offset:7680
    s_mov_b64 exec, -1
    v_exp_f32 v87, v87
    v_exp_f32 v88, v88
    v_exp_f32 v89, v89
    v_mfma_f32_32x32x16_bf16 v[200:215], v[228:231], v[76:79], v[200:215]
    v_exp_f32 v90, v90
    v_exp_f32 v91, v91
    v_exp_f32 v92, v92
    s_cmp_lg_u32 s4, 2
    s_cbranch_scc1 L_ni17
    s_nop 7
    v_mov_b32 v128, 0xff800000
    v_mov_b32 v129, 0xff800000
    v_mov_b32 v130, 0xff800000
    v_mov_b32 v131, 0xff800000
    v_mov_b32 v132, 0xff800000
    v_mov_b32 v133, 0xff800000
    v_mov_b32 v134, 0xff800000
    v_mov_b32 v135, 0xff800000
    v_mov_b32 v136, 0xff800000
    v_mov_b32 v137, 0xff800000
    v_mov_b32 v138, 0xff800000
    v_mov_b32 v139, 0xff800000
    v_mov_b32 v140, 0xff800000
    v_mov_b32 v141, 0xff800000
    v_mov_b32 v142, 0xff800000
    v_mov_b32 v143, 0xff800000
L_ni17:
    s_nop 1
    v_mfma_f32_32x32x16_bf16 v[112:127], v[164:167], v[28:31], v[128:143]
    v_exp_f32 v93, v93
    v_exp_f32 v94, v94
    v_exp_f32 v95, v95
    v_cvt_pk_bf16_f32 v80, v80, v81
    v_cvt_pk_bf16_f32 v81, v82, v83
    v_cvt_pk_bf16_f32 v82, v84, v85
    v_cvt_pk_bf16_f32 v83, v86, v87
    v_cvt_pk_bf16_f32 v84, v88, v89
    v_cvt_pk_bf16_f32 v85, v90, v91
    v_cvt_pk_bf16_f32 v86, v92, v93
    v_cvt_pk_bf16_f32 v87, v94, v95
    s_waitcnt lgkmcnt(0)
    s_cmp_lt_u32 s41, 4
    s_cbranch_scc1 L_hg17s
    s_setprio 1
    s_waitcnt vmcnt(0)
    v_mov_b32 v4, 149376
    s_mov_b64 exec, 1
    ds_add_u32 v4, v243 offset:20
    s_mov_b64 exec, -1
    v_mov_b32 v4, 149376
    s_mov_b32 s3, 262144
L_sp18:
    s_sleep 1
    s_sub_u32 s3, s3, 1
    ds_read_b32 v5, v4 offset:24
    s_waitcnt lgkmcnt(0)
    v_cmp_gt_u32 vcc, 1, v5
    s_cselect_b64 vcc, 0, vcc
    s_cbranch_vccnz L_sp18
    s_mov_b32 m0, s98
    s_add_u32 s24, s6, 63488
    buffer_load_dwordx4 v248, s[52:55], s6 offen offset:0  lds
    buffer_load_dwordx4 v248, s[52:55], s6 offen offset:1024  lds
    s_mov_b64 exec, 0xffff
    buffer_load_dwordx4 v248, s[52:55], s24 offen offset:2048  lds
    s_mov_b64 exec, -1
L_hg17s:
    s_mov_b64 exec, s[28:29]
    ds_read_b128 v[224:227], v246 offset:6144
    ds_read_b128 v[228:231], v246 offset:6656
    s_mov_b64 exec, -1
    v_exp_f32 v96, v96
    v_mfma_f32_32x32x16_bf16 v[200:215], v[216:219], v[80:83], v[200:215]
    v_exp_f32 v97, v97
    v_exp_f32 v98, v98
    v_exp_f32 v99, v99
    v_exp_f32 v100, v100
    v_exp_f32 v101, v101
    v_mfma_f32_32x32x16_bf16 v[200:215], v[220:223], v[84:87], v[200:215]
    v_exp_f32 v102, v102
    v_exp_f32 v103, v103
    v_exp_f32 v104, v104
    v_exp_f32 v105, v105
    v_exp_f32 v106, v106
    s_cmp_lg_u32 s4, 3
    s_cbranch_scc1 L_ni19
    s_nop 7
    v_mov_b32 v128, 0xff800000
    v_mov_b32 v129, 0xff800000
    v_mov_b32 v130, 0xff800000
    v_mov_b32 v131, 0xff800000
    v_mov_b32 v132, 0xff800000
    v_mov_b32 v133, 0xff800000
    v_mov_b32 v134, 0xff800000
    v_mov_b32 v135, 0xff800000
    v_mov_b32 v136, 0xff800000
    v_mov_b32 v137, 0xff800000
    v_mov_b32 v138, 0xff800000
    v_mov_b32 v139, 0xff800000
    v_mov_b32 v140, 0xff800000
    v_mov_b32 v141, 0xff800000
    v_mov_b32 v142, 0xff800000
    v_mov_b32 v143, 0xff800000
L_ni19:
    s_nop 1
    v_mfma_f32_32x32x16_bf16 v[80:95], v[160:163], v[28:31], v[128:143]
    v_exp_f32 v107, v107
    v_exp_f32 v108, v108
    v_exp_f32 v109, v109
    v_exp_f32 v110, v110
    v_exp_f32 v111, v111
    v_cvt_pk_bf16_f32 v96, v96, v97
    v_cvt_pk_bf16_f32 v97, v98, v99
    v_cvt_pk_bf16_f32 v98, v100, v101
    v_cvt_pk_bf16_f32 v99, v102, v103
    v_cvt_pk_bf16_f32 v100, v104, v105
    v_cvt_pk_bf16_f32 v101, v106, v107
    v_cvt_pk_bf16_f32 v102, v108, v109
    v_cvt_pk_bf16_f32 v103, v110, v111
    s_waitcnt lgkmcnt(0)
    s_cmp_lg_u32 s20, 1
    s_cbranch_scc1 L_hg016s
    s_mov_b64 exec, 3
    v_lshlrev_b32 v5, 11, v1
    v_add_u32 v5, 65536, v5
    buffer_load_dword v250, v5, s[52:55], s6 offen offset:256 sc1
    s_mov_b64 exec, -1
L_hg016s:
    s_mov_b64 exec, s[28:29]
    ds_read_b128 v[216:219], v246 offset:5120
    ds_read_b128 v[220:223], v246 offset:5632
    s_mov_b64 exec, -1
    v_exp_f32 v112, v112
    v_mfma_f32_32x32x16_bf16 v[200:215], v[224:227], v[96:99], v[200:215]
    v_exp_f32 v113, v113
    v_exp_f32 v114, v114
    v_exp_f32 v115, v115
    v_exp_f32 v116, v116
    v_exp_f32 v117, v117
    v_mfma_f32_32x32x16_bf16 v[200:215], v[228:231], v[100:103], v[200:215]
    v_exp_f32 v118, v118
    v_exp_f32 v119, v119
    v_exp_f32 v120, v120
    v_exp_f32 v121, v121
    v_exp_f32 v122, v122
    s_cmp_lg_u32 s4, 4
    s_cbranch_scc1 L_ni20
    s_nop 7
    v_mov_b32 v128, 0xff800000
    v_mov_b32 v129, 0xff800000
    v_mov_b32 v130, 0xff800000
    v_mov_b32 v131, 0xff800000
    v_mov_b32 v132, 0xff800000
    v_mov_b32 v133, 0xff800000
    v_mov_b32 v134, 0xff800000
    v_mov_b32 v135, 0xff800000
    v_mov_b32 v136, 0xff800000
    v_mov_b32 v137, 0xff800000
    v_mov_b32 v138, 0xff800000
    v_mov_b32 v139, 0xff800000
    v_mov_b32 v140, 0xff800000
    v_mov_b32 v141, 0xff800000
    v_mov_b32 v142, 0xff800000
    v_mov_b32 v143, 0xff800000
L_ni20:
    s_nop 1
    v_mfma_f32_32x32x16_bf16 v[96:111], v[156:159], v[28:31], v[128:143]
    v_exp_f32 v123, v123
    v_exp_f32 v124, v124
    v_exp_f32 v125, v125
    v_exp_f32 v126, v126
    v_exp_f32 v127, v127
    v_cvt_pk_bf16_f32 v112, v112, v113
    v_cvt_pk_bf16_f32 v113, v114, v115
    v_cvt_pk_bf16_f32 v114, v116, v117
    v_cvt_pk_bf16_f32 v115, v118, v119
    v_cvt_pk_bf16_f32 v116, v120, v121
    v_cvt_pk_bf16_f32 v117, v122, v123
    v_cvt_pk_bf16_f32 v118, v124, v125
    v_cvt_pk_bf16_f32 v119, v126, v127
    s_waitcnt lgkmcnt(0)
    s_cmp_lt_u32 s41, 4
    s_cbranch_scc1 L_hg15s
    v_xor_b32 v36, 16, v242
    v_xor_b32 v40, 32, v242
    v_xor_b32 v44, 48, v242
    s_waitcnt vmcnt(0)
    ds_read_b128 v[32:35], v242
    ds_read_b128 v[36:39], v36
    ds_read_b128 v[40:43], v40
    ds_read_b128 v[44:47], v44
L_hg15s:
    s_mov_b64 exec, s[28:29]
    ds_read_b128 v[224:227], v246 offset:4096
    ds_read_b128 v[228:231], v246 offset:4608
    s_mov_b64 exec, -1
    v_exp_f32 v80, v80
    v_mfma_f32_32x32x16_bf16 v[200:215], v[216:219], v[112:115], v[200:215]
    v_exp_f32 v81, v81
    v_exp_f32 v82, v82
    v_exp_f32 v83, v83
    v_exp_f32 v84, v84
    v_exp_f32 v85, v85
    v_mfma_f32_32x32x16_bf16 v[200:215], v[220:223], v[116:119], v[200:215]
    v_exp_f32 v86, v86
    v_exp_f32 v87, v87
    v_exp_f32 v88, v88
    v_exp_f32 v89, v89
    v_exp_f32 v90, v90
    s_cmp_lg_u32 s4, 5
    s_cbranch_scc1 L_ni21
    s_nop 7
    v_mov_b32 v128, 0xff800000
    v_mov_b32 v129, 0xff800000
    v_mov_b32 v130, 0xff800000
    v_mov_b32 v131, 0xff800000
    v_mov_b32 v132, 0xff800000
    v_mov_b32 v133, 0xff800000
    v_mov_b32 v134, 0xff800000
    v_mov_b32 v135, 0xff800000
    v_mov_b32 v136, 0xff800000
    v_mov_b32 v137, 0xff800000
    v_mov_b32 v138, 0xff800000
    v_mov_b32 v139, 0xff800000
    v_mov_b32 v140, 0xff800000
    v_mov_b32 v141, 0xff800000
    v_mov_b32 v142, 0xff800000
    v_mov_b32 v143, 0xff800000
L_ni21:
    s_nop 1
    v_mfma_f32_32x32x16_bf16 v[112:127], v[152:155], v[28:31], v[128:143]
    v_exp_f32 v91, v91
    v_exp_f32 v92, v92
    v_exp_f32 v93, v93
    v_exp_f32 v94, v94
    v_exp_f32 v95, v95
    v_cvt_pk_bf16_f32 v80, v80, v81
    v_cvt_pk_bf16_f32 v81, v82, v83
    v_cvt_pk_bf16_f32 v82, v84, v85
    v_cvt_pk_bf16_f32 v83, v86, v87
    v_cvt_pk_bf16_f32 v84, v88, v89
    v_cvt_pk_bf16_f32 v85, v90, v91
    v_cvt_pk_bf16_f32 v86, v92, v93
    v_cvt_pk_bf16_f32 v87, v94, v95
    s_waitcnt lgkmcnt(0)
    s_cmp_lg_u32 s20, 0
    s_cbranch_scc1 L_hg004s
    s_mov_b64 exec, 3
    v_lshlrev_b32 v5, 11, v1
    v_add_u32 v5, 65536, v5
    buffer_load_dword v250, v5, s[52:55], s6 offen offset:256 sc1
    s_mov_b64 exec, -1
L_hg004s:
    s_cmp_lt_u32 s41, 4
    s_cbranch_scc1 L_hg14s
    v_cvt_pk_bf16_f32 v32, v32, v33
    v_cvt_pk_bf16_f32 v33, v34, v35
    v_cvt_pk_bf16_f32 v34, v36, v37
    v_cvt_pk_bf16_f32 v35, v38, v39
    v_cvt_pk_bf16_f32 v36, v40, v41
    v_cvt_pk_bf16_f32 v37, v42, v43
    v_cvt_pk_bf16_f32 v38, v44, v45
    v_cvt_pk_bf16_f32 v39, v46, v47
    v_mfma_f32_32x32x16_bf16 v[64:79], v[32:35], v[48:51], 0
    s_nop 0
    v_mfma_f32_32x32x16_bf16 v[180:195], v[36:39], v[52:55], 0
L_hg14s:
    s_mov_b64 exec, s[28:29]
    ds_read_b128 v[216:219], v246 offset:3072
    ds_read_b128 v[220:223], v246 offset:3584
    s_mov_b64 exec, -1
    v_exp_f32 v96, v96
    v_mfma_f32_32x32x16_bf16 v[200:215], v[224:227], v[80:83], v[200:215]
    v_exp_f32 v97, v97
    v_exp_f32 v98, v98
    v_exp_f32 v99, v99
    v_exp_f32 v100, v100
    v_exp_f32 v101, v101
    v_mfma_f32_32x32x16_bf16 v[200:215], v[228:231], v[84:87], v[200:215]
    v_exp_f32 v102, v102
    v_exp_f32 v103, v103
    v_exp_f32 v104, v104
    v_exp_f32 v105, v105
    v_exp_f32 v106, v106
    s_cmp_lg_u32 s4, 6
    s_cbranch_scc1 L_ni22
    s_nop 7
    v_mov_b32 v128, 0xff800000
    v_mov_b32 v129, 0xff800000
    v_mov_b32 v130, 0xff800000
    v_mov_b32 v131, 0xff800000
    v_mov_b32 v132, 0xff800000
    v_mov_b32 v133, 0xff800000
    v_mov_b32 v134, 0xff800000
    v_mov_b32 v135, 0xff800000
    v_mov_b32 v136, 0xff800000
    v_mov_b32 v137, 0xff800000
    v_mov_b32 v138, 0xff800000
    v_mov_b32 v139, 0xff800000
    v_mov_b32 v140, 0xff800000
    v_mov_b32 v141, 0xff800000
    v_mov_b32 v142, 0xff800000
    v_mov_b32 v143, 0xff800000
L_ni22:
    s_nop 1
    v_mfma_f32_32x32x16_bf16 v[80:95], v[148:151], v[28:31], v[128:143]
    v_exp_f32 v107, v107
    v_exp_f32 v108, v108
    v_exp_f32 v109, v109
    v_exp_f32 v110, v110
    v_exp_f32 v111, v111
    v_cvt_pk_bf16_f32 v96, v96, v97
    v_cvt_pk_bf16_f32 v97, v98, v99
    v_cvt_pk_bf16_f32 v98, v100, v101
    v_cvt_pk_bf16_f32 v99, v102, v103
    v_cvt_pk_bf16_f32 v100, v104, v105
    v_cvt_pk_bf16_f32 v101, v106, v107
    v_cvt_pk_bf16_f32 v102, v108, v109
    v_cvt_pk_bf16_f32 v103, v110, v111
    s_waitcnt lgkmcnt(0)
    s_cmp_lg_u32 s20, 1
    s_cbranch_scc1 L_hg013s
    s_mov_b64 exec, 3
    s_waitcnt vmcnt(0)
    v_cmp_ne_u32 vcc, 16, v250
    s_cbranch_vccnz L_ps23
L_pd23:
    v_mov_b32 v4, 149376
    s_mov_b64 exec, 1
    ds_add_u32 v4, v243 offset:24
    s_mov_b64 exec, -1
    s_setprio 2
    s_mov_b32 m0, s98
    s_add_u32 s24, s6, 63488
    buffer_load_dwordx4 v248, s[52:55], s6 offen offset:0  lds
    buffer_load_dwordx4 v248, s[52:55], s6 offen offset:1024  lds
    s_mov_b64 exec, 0xffff
    buffer_load_dwordx4 v248, s[52:55], s24 offen offset:2048  lds
    s_mov_b64 exec, -1
L_hg013s:
    s_cmp_lt_u32 s41, 4
    s_cbranch_scc1 L_hg13s
    v_mov_b32 v6, 0x358637bd
    v_rcp_f32 v4, v73
    v_rcp_f32 v5, v189
    v_fmac_f32 v6, v72, v4
    v_fmac_f32 v6, v188, v5
    v_rcp_f32 v6, v6
    s_nop 0
    v_mul_f32 v4, v4, v6
    v_mul_f32 v5, v5, v6
    v_mul_f32 v64, v64, v4
    v_mul_f32 v65, v65, v4
    v_mul_f32 v66, v66, v4
    v_mul_f32 v67, v67, v4
    v_mul_f32 v68, v68, v4
    v_mul_f32 v69, v69, v4
    v_mul_f32 v70, v70, v4
    v_mul_f32 v71, v71, v4
    v_fmac_f32 v64, v180, v5
    v_fmac_f32 v65, v181, v5
    v_fmac_f32 v66, v182, v5
    v_fmac_f32 v67, v183, v5
    v_fmac_f32 v68, v184, v5
    v_fmac_f32 v69, v185, v5
    v_fmac_f32 v70, v186, v5
    v_fmac_f32 v71, v187, v5
    v_cvt_pk_bf16_f32 v20, v64, v65
    v_cvt_pk_bf16_f32 v21, v66, v67
    v_cvt_pk_bf16_f32 v22, v68, v69
    v_cvt_pk_bf16_f32 v23, v70, v71
    buffer_store_dwordx4 v[20:23], v8, s[52:55], s7 offen sc1
L_hg13s:
    s_mov_b64 exec, s[28:29]
    ds_read_b128 v[224:227], v246 offset:2048
    ds_read_b128 v[228:231], v246 offset:2560
    s_mov_b64 exec, -1
    v_exp_f32 v112, v112
    v_mfma_f32_32x32x16_bf16 v[200:215], v[216:219], v[96:99], v[200:215]
    v_exp_f32 v113, v113
    v_exp_f32 v114, v114
    v_exp_f32 v115, v115
    v_exp_f32 v116, v116
    v_exp_f32 v117, v117
    v_exp_f32 v118, v118
    v_exp_f32 v119, v119
    v_exp_f32 v120, v120
    v_mfma_f32_32x32x16_bf16 v[200:215], v[220:223], v[100:103], v[200:215]
    v_exp_f32 v121, v121
    v_exp_f32 v122, v122
    v_exp_f32 v123, v123
    v_exp_f32 v124, v124
    v_exp_f32 v125, v125
    v_exp_f32 v126, v126
    v_exp_f32 v127, v127
    v_cvt_pk_bf16_f32 v112, v112, v113
    v_cvt_pk_bf16_f32 v113, v114, v115
    v_cvt_pk_bf16_f32 v114, v116, v117
    v_cvt_pk_bf16_f32 v115, v118, v119
    v_cvt_pk_bf16_f32 v116, v120, v121
    v_cvt_pk_bf16_f32 v117, v122, v123
    v_cvt_pk_bf16_f32 v118, v124, v125
    v_cvt_pk_bf16_f32 v119, v126, v127
    s_waitcnt lgkmcnt(0)
    s_cmp_lg_u32 s20, 0
    s_cbranch_scc1 L_hg002s
    s_mov_b64 exec, 3
    s_waitcnt vmcnt(0)
    v_cmp_ne_u32 vcc, 16, v250
    s_cbranch_vccnz L_ps24
L_pd24:
    v_mov_b32 v4, 149376
    s_mov_b64 exec, 1
    ds_add_u32 v4, v243 offset:24
    s_mov_b64 exec, -1
    s_setprio 2
    s_mov_b32 m0, s98
    s_add_u32 s24, s6, 63488
    buffer_load_dwordx4 v248, s[52:55], s6 offen offset:0  lds
    buffer_load_dwordx4 v248, s[52:55], s6 offen offset:1024  lds
    s_mov_b64 exec, 0xffff
    buffer_load_dwordx4 v248, s[52:55], s24 offen offset:2048  lds
    s_mov_b64 exec, -1
L_hg002s:
    s_mov_b64 exec, s[28:29]
    ds_read_b128 v[216:219], v246 offset:1024
    ds_read_b128 v[220:223], v246 offset:1536
    s_mov_b64 exec, -1
    v_exp_f32 v80, v80
    v_mfma_f32_32x32x16_bf16 v[200:215], v[224:227], v[112:115], v[200:215]
    v_exp_f32 v81, v81
    v_exp_f32 v82, v82
    v_exp_f32 v83, v83
    v_exp_f32 v84, v84
    v_exp_f32 v85, v85
    v_exp_f32 v86, v86
    v_exp_f32 v87, v87
    v_exp_f32 v88, v88
    v_mfma_f32_32x32x16_bf16 v[200:215], v[228:231], v[116:119], v[200:215]
    v_exp_f32 v89, v89
    v_exp_f32 v90, v90
    v_exp_f32 v91, v91
    v_exp_f32 v92, v92
    v_exp_f32 v93, v93
    v_exp_f32 v94, v94
    v_exp_f32 v95, v95
    v_cvt_pk_bf16_f32 v80, v80, v81
    v_cvt_pk_bf16_f32 v81, v82, v83
    v_cvt_pk_bf16_f32 v82, v84, v85
    v_cvt_pk_bf16_f32 v83, v86, v87
    v_cvt_pk_bf16_f32 v84, v88, v89
    v_cvt_pk_bf16_f32 v85, v90, v91
    v_cvt_pk_bf16_f32 v86, v92, v93
    v_cvt_pk_bf16_f32 v87, v94, v95
    s_waitcnt lgkmcnt(1)
    v_mfma_f32_32x32x16_bf16 v[200:215], v[216:219], v[80:83], v[200:215]
    s_waitcnt lgkmcnt(0)
    v_mfma_f32_32x32x16_bf16 v[200:215], v[220:223], v[84:87], v[200:215]
    s_branch L_bdone
L_d4:
L_pad10:
    s_cbranch_execz L_padret1
    s_mov_b64 exec, 1
    s_cmp_lg_u32 s41, 1
    s_cbranch_scc1 L_d6
    s_waitcnt vmcnt(0)
    buffer_atomic_add v243, v244, s[56:59], 0 offen offset:4
L_d6:
    s_cmp_lg_u32 s41, 3
    s_cbranch_scc1 L_d7
    s_cmp_lg_u32 s2, 0
    s_cbranch_scc1 L_d7
    s_waitcnt vmcnt(0)
    v_add_u32 v250, 8, v250
    v_and_b32 v250, -8, v250
    v_max_u32 v250, 8, v250
    v_or_b32 v250, s99, v250
    s_mov_b32 s24, 17956864
    buffer_store_dword v250, v244, s[56:59], 0 offen sc1
    buffer_store_dword v250, v244, s[52:55], s24 offen sc1
L_d7:
    s_mov_b64 exec, -1
    s_branch L_d5
L_tgw:
    s_mov_b32 s3, 65536
L_tg:
    s_sleep 1
    buffer_load_dwordx2 v[24:25], v244, s[56:59], 0 offen sc1
    s_waitcnt vmcnt(0)
    v_readfirstlane_b32 s60, v24
    v_readfirstlane_b32 s61, v25
    s_and_b32 s24, s61, 0xffff
    s_cmp_lg_u32 s60, 0
    s_cselect_b32 s24, s24, 0
    s_cmp_lt_u32 s24, 64
    s_cselect_b32 s3, s3, 0
    s_sub_u32 s3, s3, 1
    s_cbranch_scc0 L_tg
    s_branch L_tgd
L_gs3:
    s_mov_b32 s3, 0
L_gl3:
    s_sleep 2
    buffer_load_dwordx4 v[32:35], v8, s[52:55], s15 offen offset:0 sc1
    buffer_load_dwordx4 v[36:39], v8, s[52:55], s15 offen offset:1024 sc1
    buffer_load_dwordx4 v[40:43], v8, s[52:55], s15 offen offset:2048 sc1
    s_waitcnt vmcnt(0)
    v_cmp_ne_u32_e64 s[24:25], s60, v35
    v_cmp_ne_u32 vcc, s60, v39
    s_or_b64 s[24:25], s[24:25], vcc
    v_cmp_ne_u32 vcc, s60, v43
    s_or_b64 s[24:25], s[24:25], vcc
    s_cbranch_scc0 L_gd3
    s_add_u32 s3, s3, 1
    s_cmp_lt_u32 s3, 65536
    s_cbranch_scc1 L_gl3
    s_branch L_gd3
L_nbB:
L_pad11:
    s_cbranch_execz L_padret1
    v_mov_b32 v48, 0
    v_mov_b32 v49, 0
    v_mov_b32 v50, 0
    v_mov_b32 v51, 0
    v_add_u32 v7, s27, v8
    ds_write_b128 v7, v[48:51] offset:0
    ds_write_b128 v7, v[48:51] offset:1024
    ds_write_b128 v7, v[48:51] offset:2048
    ds_write_b128 v7, v[48:51] offset:3072
    s_cmp_eq_u32 s39, 1
    s_cbranch_scc1 L_nb2B
    ds_write_b128 v7, v[48:51] offset:4096
    ds_write_b128 v7, v[48:51] offset:5120
    ds_write_b128 v7, v[48:51] offset:6144
    ds_write_b128 v7, v[48:51] offset:7168
    s_branch L_nb2B
L_nbA:
L_pad12:
    s_cbranch_execz L_padret1
    v_mov_b32 v48, 0
    v_mov_b32 v49, 0
    v_mov_b32 v50, 0
    v_mov_b32 v51, 0
    v_add_u32 v7, s27, v8
    ds_write_b128 v7, v[48:51] offset:0
    ds_write_b128 v7, v[48:51] offset:1024
    ds_write_b128 v7, v[48:51] offset:2048
    ds_write_b128 v7, v[48:51] offset:3072
    s_cmp_eq_u32 s39, 1
    s_cbranch_scc1 L_nb2A
    ds_write_b128 v7, v[48:51] offset:4096
    ds_write_b128 v7, v[48:51] offset:5120
    ds_write_b128 v7, v[48:51] offset:6144
    ds_write_b128 v7, v[48:51] offset:7168
    s_branch L_nb2A
L_exs:
    s_mov_b32 s3, 262144
L_exs2:
    ds_read_b32 v50, v49
    ds_read_b128 v[152:155], v53
    ds_read_b128 v[156:159], v53 offset:1024
    ds_read_b32 v144, v53 offset:2048
    s_sub_u32 s3, s3, 1
    s_waitcnt lgkmcnt(0)
    v_cmp_eq_u32 vcc, 0, v50
    s_cselect_b64 vcc, 0, vcc
    s_cbranch_vccnz L_exs2
    s_branch L_exd
L_ps9:
    s_mov_b32 s3, 0
L_pl9:
    s_sleep 2
    buffer_load_dword v250, v5, s[52:55], s6 offen offset:256 sc1
    s_add_u32 s3, s3, 1
    s_waitcnt vmcnt(0)
    v_cmp_ne_u32 vcc, 16, v250
    s_cbranch_vccz L_pd9
    s_cmp_lt_u32 s3, 65536
    s_cbranch_scc1 L_pl9
    s_branch L_pd9
L_ps10:
    s_mov_b32 s3, 0
L_pl10:
    s_sleep 2
    buffer_load_dword v250, v5, s[52:55], s6 offen offset:256 sc1
    s_add_u32 s3, s3, 1
    s_waitcnt vmcnt(0)
    v_cmp_ne_u32 vcc, 16, v250
    s_cbranch_vccz L_pd10
    s_cmp_lt_u32 s3, 65536
    s_cbranch_scc1 L_pl10
    s_branch L_pd10
L_ps23:
    s_mov_b32 s3, 0
L_pl23:
    s_sleep 2
    buffer_load_dword v250, v5, s[52:55], s6 offen offset:256 sc1
    s_add_u32 s3, s3, 1
    s_waitcnt vmcnt(0)
    v_cmp_ne_u32 vcc, 16, v250
    s_cbranch_vccz L_pd23
    s_cmp_lt_u32 s3, 65536
    s_cbranch_scc1 L_pl23
    s_branch L_pd23
L_ps24:
    s_mov_b32 s3, 0
L_pl24:
    s_sleep 2
    buffer_load_dword v250, v5, s[52:55], s6 offen offset:256 sc1
    s_add_u32 s3, s3, 1
    s_waitcnt vmcnt(0)
    v_cmp_ne_u32 vcc, 16, v250
    s_cbranch_vccz L_pd24
    s_cmp_lt_u32 s3, 65536
    s_cbranch_scc1 L_pl24
    s_branch L_pd24
L_cold:
L_bexact:
    ds_read_b128 v[176:179], v245 offset:8192
    ds_read_b128 v[144:147], v245 offset:0
    ds_read_b128 v[172:175], v245 offset:7168
    ds_read_b128 v[168:171], v245 offset:6144
    ds_read_b128 v[164:167], v245 offset:5120
    ds_read_b128 v[160:163], v245 offset:4096
    ds_read_b128 v[156:159], v245 offset:3072
    ds_read_b128 v[152:155], v245 offset:2048
    ds_read_b128 v[148:151], v245 offset:1024
    s_waitcnt lgkmcnt(8)
    v_mfma_f32_32x32x16_bf16 v[64:79], v[176:179], v[28:31], 0
    s_waitcnt lgkmcnt(7)
    v_mfma_f32_32x32x16_bf16 v[80:95], v[144:147], v[28:31], 0
    s_waitcnt lgkmcnt(6)
    v_mfma_f32_32x32x16_bf16 v[96:111], v[172:175], v[28:31], 0
    s_waitcnt lgkmcnt(5)
    v_mfma_f32_32x32x16_bf16 v[112:127], v[168:171], v[28:31], 0
    s_waitcnt lgkmcnt(4)
    v_mfma_f32_32x32x16_bf16 v[128:143], v[164:167], v[28:31], 0
    s_cmp_ge_u32 s4, 8
    s_cbranch_scc1 L_t0x
    s_nop 7
    v_mov_b32 v80, 0xff800000
    v_mov_b32 v81, 0xff800000
    v_mov_b32 v82, 0xff800000
    v_mov_b32 v83, 0xff800000
    v_mov_b32 v84, 0xff800000
    v_mov_b32 v85, 0xff800000
    v_mov_b32 v86, 0xff800000
    v_mov_b32 v87, 0xff800000
    v_mov_b32 v88, 0xff800000
    v_mov_b32 v89, 0xff800000
    v_mov_b32 v90, 0xff800000
    v_mov_b32 v91, 0xff800000
    v_mov_b32 v92, 0xff800000
    v_mov_b32 v93, 0xff800000
    v_mov_b32 v94, 0xff800000
    v_mov_b32 v95, 0xff800000
L_t0x:
    s_nop 7
    v_cndmask_b32_e64 v64, v80, v64, s[64:65]
    v_cndmask_b32_e64 v65, v81, v65, s[66:67]
    v_cndmask_b32_e64 v66, v82, v66, s[68:69]
    v_cndmask_b32_e64 v67, v83, v67, s[70:71]
    v_cndmask_b32_e64 v68, v84, v68, s[72:73]
    v_cndmask_b32_e64 v69, v85, v69, s[74:75]
    v_cndmask_b32_e64 v70, v86, v70, s[76:77]
    v_cndmask_b32_e64 v71, v87, v71, s[78:79]
    v_cndmask_b32_e64 v72, v88, v72, s[80:81]
    v_cndmask_b32_e64 v73, v89, v73, s[82:83]
    v_cndmask_b32_e64 v74, v90, v74, s[84:85]
    v_cndmask_b32_e64 v75, v91, v75, s[86:87]
    v_cndmask_b32_e64 v76, v92, v76, s[88:89]
    v_cndmask_b32_e64 v77, v93, v77, s[90:91]
    v_cndmask_b32_e64 v78, v94, v78, s[92:93]
    v_cndmask_b32_e64 v79, v95, v79, s[94:95]
    s_waitcnt lgkmcnt(3)
    v_mfma_f32_32x32x16_bf16 v[80:95], v[160:163], v[28:31], 0
    v_max_f32 v2, v64, v65
    v_max_f32 v3, v66, v67
    v_max3_f32 v2, v2, v68, v69
    v_max3_f32 v3, v3, v70, v71
    v_max3_f32 v2, v2, v72, v73
    v_max3_f32 v3, v3, v74, v75
    v_max3_f32 v2, v2, v76, v77
    v_max3_f32 v3, v3, v78, v79
    s_cmp_lt_u32 s4, 1
    s_cbranch_scc1 L_bmx
    v_max3_f32 v2, v2, v96, v97
    v_max3_f32 v3, v3, v98, v99
    v_max3_f32 v2, v2, v100, v101
    v_max3_f32 v3, v3, v102, v103
    v_max3_f32 v2, v2, v104, v105
    v_max3_f32 v3, v3, v106, v107
    v_max3_f32 v2, v2, v108, v109
    v_max3_f32 v3, v3, v110, v111
    s_waitcnt lgkmcnt(2)
    v_mfma_f32_32x32x16_bf16 v[96:111], v[156:159], v[28:31], 0
    s_cmp_lt_u32 s4, 2
    s_cbranch_scc1 L_bmx
    v_max3_f32 v2, v2, v112, v113
    v_max3_f32 v3, v3, v114, v115
    v_max3_f32 v2, v2, v116, v117
    v_max3_f32 v3, v3, v118, v119
    v_max3_f32 v2, v2, v120, v121
    v_max3_f32 v3, v3, v122, v123
    v_max3_f32 v2, v2, v124, v125
    v_max3_f32 v3, v3, v126, v127
    s_waitcnt lgkmcnt(1)
    v_mfma_f32_32x32x16_bf16 v[112:127], v[152:155], v[28:31], 0
    s_cmp_lt_u32 s4, 3
    s_cbranch_scc1 L_bmx
    v_max3_f32 v2, v2, v128, v129
    v_max3_f32 v3, v3, v130, v131
    v_max3_f32 v2, v2, v132, v133
    v_max3_f32 v3, v3, v134, v135
    v_max3_f32 v2, v2, v136, v137
    v_max3_f32 v3, v3, v138, v139
    v_max3_f32 v2, v2, v140, v141
    v_max3_f32 v3, v3, v142, v143
    s_waitcnt lgkmcnt(0)
    v_mfma_f32_32x32x16_bf16 v[128:143], v[148:151], v[28:31], 0
    s_cmp_lt_u32 s4, 4
    s_cbranch_scc1 L_bmx
    v_max3_f32 v2, v2, v80, v81
    v_max3_f32 v3, v3, v82, v83
    v_max3_f32 v2, v2, v84, v85
    v_max3_f32 v3, v3, v86, v87
    v_max3_f32 v2, v2, v88, v89
    v_max3_f32 v3, v3, v90, v91
    v_max3_f32 v2, v2, v92, v93
    v_max3_f32 v3, v3, v94, v95
    s_cmp_lt_u32 s4, 5
    s_cbranch_scc1 L_bmx
    v_max3_f32 v2, v2, v96, v97
    v_max3_f32 v3, v3, v98, v99
    v_max3_f32 v2, v2, v100, v101
    v_max3_f32 v3, v3, v102, v103
    v_max3_f32 v2, v2, v104, v105
    v_max3_f32 v3, v3, v106, v107
    v_max3_f32 v2, v2, v108, v109
    v_max3_f32 v3, v3, v110, v111
    s_cmp_lt_u32 s4, 6
    s_cbranch_scc1 L_bmx
    v_max3_f32 v2, v2, v112, v113
    v_max3_f32 v3, v3, v114, v115
    v_max3_f32 v2, v2, v116, v117
    v_max3_f32 v3, v3, v118, v119
    v_max3_f32 v2, v2, v120, v121
    v_max3_f32 v3, v3, v122, v123
    v_max3_f32 v2, v2, v124, v125
    v_max3_f32 v3, v3, v126, v127
    s_cmp_lt_u32 s4, 7
    s_cbranch_scc1 L_bmx
    v_max3_f32 v2, v2, v128, v129
    v_max3_f32 v3, v3, v130, v131
    v_max3_f32 v2, v2, v132, v133
    v_max3_f32 v3, v3, v134, v135
    v_max3_f32 v2, v2, v136, v137
    v_max3_f32 v3, v3, v138, v139
    v_max3_f32 v2, v2, v140, v141
    v_max3_f32 v3, v3, v142, v143
L_bmx:
    s_waitcnt lgkmcnt(0)
    s_nop 15
    v_max_f32 v2, v2, v3
    v_mov_b32 v3, v2
    s_nop 1
    v_permlane32_swap_b32 v2, v3
    v_max_f32 v2, v2, v3
    v_sub_f32 v128, 0, v2
    v_sub_f32 v129, 0, v2
    v_mov_b64 v[130:131], v[128:129]
    v_mov_b64 v[132:133], v[128:129]
    v_mov_b64 v[134:135], v[128:129]
    v_mov_b64 v[136:137], v[128:129]
    v_mov_b64 v[138:139], v[128:129]
    v_mov_b64 v[140:141], v[128:129]
    v_mov_b64 v[142:143], v[128:129]
    s_mov_b64 exec, s[28:29]
    ds_read_b128 v[216:219], v246 offset:8192
    ds_read_b128 v[220:223], v246 offset:8704
    ds_read_b128 v[224:227], v246 offset:0
    ds_read_b128 v[228:231], v246 offset:512
    s_mov_b64 exec, -1
    v_sub_f32 v64, v64, v2
    v_sub_f32 v65, v65, v2
    v_sub_f32 v66, v66, v2
    v_sub_f32 v67, v67, v2
    v_sub_f32 v68, v68, v2
    v_sub_f32 v69, v69, v2
    v_sub_f32 v70, v70, v2
    v_sub_f32 v71, v71, v2
    v_sub_f32 v72, v72, v2
    v_sub_f32 v73, v73, v2
    v_sub_f32 v74, v74, v2
    v_sub_f32 v75, v75, v2
    v_sub_f32 v76, v76, v2
    v_sub_f32 v77, v77, v2
    v_sub_f32 v78, v78, v2
    v_sub_f32 v79, v79, v2
    v_exp_f32 v64, v64
    s_cmp_lg_u32 s4, 0
    s_cbranch_scc1 L_ni25
    s_nop 7
    v_mov_b32 v128, 0xff800000
    v_mov_b32 v129, 0xff800000
    v_mov_b32 v130, 0xff800000
    v_mov_b32 v131, 0xff800000
    v_mov_b32 v132, 0xff800000
    v_mov_b32 v133, 0xff800000
    v_mov_b32 v134, 0xff800000
    v_mov_b32 v135, 0xff800000
    v_mov_b32 v136, 0xff800000
    v_mov_b32 v137, 0xff800000
    v_mov_b32 v138, 0xff800000
    v_mov_b32 v139, 0xff800000
    v_mov_b32 v140, 0xff800000
    v_mov_b32 v141, 0xff800000
    v_mov_b32 v142, 0xff800000
    v_mov_b32 v143, 0xff800000
L_ni25:
    s_nop 1
    v_mfma_f32_32x32x16_bf16 v[80:95], v[172:175], v[28:31], v[128:143]
    v_exp_f32 v65, v65
    v_exp_f32 v66, v66
    v_exp_f32 v67, v67
    v_exp_f32 v68, v68
    v_exp_f32 v69, v69
    v_exp_f32 v70, v70
    v_exp_f32 v71, v71
    v_exp_f32 v72, v72
    s_cmp_lg_u32 s4, 1
    s_cbranch_scc1 L_ni26
    s_nop 7
    v_mov_b32 v128, 0xff800000
    v_mov_b32 v129, 0xff800000
    v_mov_b32 v130, 0xff800000
    v_mov_b32 v131, 0xff800000
    v_mov_b32 v132, 0xff800000
    v_mov_b32 v133, 0xff800000
    v_mov_b32 v134, 0xff800000
    v_mov_b32 v135, 0xff800000
    v_mov_b32 v136, 0xff800000
    v_mov_b32 v137, 0xff800000
    v_mov_b32 v138, 0xff800000
    v_mov_b32 v139, 0xff800000
    v_mov_b32 v140, 0xff800000
    v_mov_b32 v141, 0xff800000
    v_mov_b32 v142, 0xff800000
    v_mov_b32 v143, 0xff800000
L_ni26:
    s_nop 1
    v_mfma_f32_32x32x16_bf16 v[96:111], v[168:171], v[28:31], v[128:143]
    v_exp_f32 v73, v73
    v_exp_f32 v74, v74
    v_exp_f32 v75, v75
    v_exp_f32 v76, v76
    v_exp_f32 v77, v77
    v_exp_f32 v78, v78
    v_exp_f32 v79, v79
    v_cvt_pk_bf16_f32 v64, v64, v65
    v_cvt_pk_bf16_f32 v65, v66, v67
    v_cvt_pk_bf16_f32 v66, v68, v69
    v_cvt_pk_bf16_f32 v67, v70, v71
    v_cvt_pk_bf16_f32 v68, v72, v73
    v_cvt_pk_bf16_f32 v69, v74, v75
    v_cvt_pk_bf16_f32 v70, v76, v77
    v_cvt_pk_bf16_f32 v71, v78, v79
    v_bfi_b32 v72, v232, 0, v64
    v_bfi_b32 v73, v233, 0, v65
    v_bfi_b32 v74, v234, 0, v66
    v_bfi_b32 v75, v235, 0, v67
    v_bfi_b32 v76, v236, 0, v68
    v_bfi_b32 v77, v237, 0, v69
    v_bfi_b32 v78, v238, 0, v70
    v_bfi_b32 v79, v239, 0, v71
    v_and_b32 v64, v232, v64
    v_and_b32 v65, v233, v65
    v_and_b32 v66, v234, v66
    v_and_b32 v67, v235, v67
    v_and_b32 v68, v236, v68
    v_and_b32 v69, v237, v69
    v_and_b32 v70, v238, v70
    v_and_b32 v71, v239, v71
    s_waitcnt lgkmcnt(0)
    v_exp_f32 v80, v80
    v_mfma_f32_32x32x16_bf16 v[200:215], v[216:219], v[64:67], 0
    v_exp_f32 v81, v81
    v_exp_f32 v82, v82
    v_exp_f32 v83, v83
    v_mfma_f32_32x32x16_bf16 v[200:215], v[220:223], v[68:71], v[200:215]
    v_exp_f32 v84, v84
    v_exp_f32 v85, v85
    v_exp_f32 v86, v86
    v_mfma_f32_32x32x16_bf16 v[200:215], v[224:227], v[72:75], v[200:215]
    s_mov_b64 exec, s[28:29]
    ds_read_b128 v[216:219], v246 offset:7168
    ds_read_b128 v[220:223], v246 offset:7680
    s_mov_b64 exec, -1
    v_exp_f32 v87, v87
    v_exp_f32 v88, v88
    v_exp_f32 v89, v89
    v_mfma_f32_32x32x16_bf16 v[200:215], v[228:231], v[76:79], v[200:215]
    v_exp_f32 v90, v90
    v_exp_f32 v91, v91
    v_exp_f32 v92, v92
    s_cmp_lg_u32 s4, 2
    s_cbranch_scc1 L_ni27
    s_nop 7
    v_mov_b32 v128, 0xff800000
    v_mov_b32 v129, 0xff800000
    v_mov_b32 v130, 0xff800000
    v_mov_b32 v131, 0xff800000
    v_mov_b32 v132, 0xff800000
    v_mov_b32 v133, 0xff800000
    v_mov_b32 v134, 0xff800000
    v_mov_b32 v135, 0xff800000
    v_mov_b32 v136, 0xff800000
    v_mov_b32 v137, 0xff800000
    v_mov_b32 v138, 0xff800000
    v_mov_b32 v139, 0xff800000
    v_mov_b32 v140, 0xff800000
    v_mov_b32 v141, 0xff800000
    v_mov_b32 v142, 0xff800000
    v_mov_b32 v143, 0xff800000
L_ni27:
    s_nop 1
    v_mfma_f32_32x32x16_bf16 v[112:127], v[164:167], v[28:31], v[128:143]
    v_exp_f32 v93, v93
    v_exp_f32 v94, v94
    v_exp_f32 v95, v95
    v_cvt_pk_bf16_f32 v80, v80, v81
    v_cvt_pk_bf16_f32 v81, v82, v83
    v_cvt_pk_bf16_f32 v82, v84, v85
    v_cvt_pk_bf16_f32 v83, v86, v87
    v_cvt_pk_bf16_f32 v84, v88, v89
    v_cvt_pk_bf16_f32 v85, v90, v91
    v_cvt_pk_bf16_f32 v86, v92, v93
    v_cvt_pk_bf16_f32 v87, v94, v95
    s_waitcnt lgkmcnt(0)
    s_mov_b64 exec, s[28:29]
    ds_read_b128 v[224:227], v246 offset:6144
    ds_read_b128 v[228:231], v246 offset:6656
    s_mov_b64 exec, -1
    v_exp_f32 v96, v96
    v_mfma_f32_32x32x16_bf16 v[200:215], v[216:219], v[80:83], v[200:215]
    v_exp_f32 v97, v97
    v_exp_f32 v98, v98
    v_exp_f32 v99, v99
    v_exp_f32 v100, v100
    v_exp_f32 v101, v101
    v_mfma_f32_32x32x16_bf16 v[200:215], v[220:223], v[84:87], v[200:215]
    v_exp_f32 v102, v102
    v_exp_f32 v103, v103
    v_exp_f32 v104, v104
    v_exp_f32 v105, v105
    v_exp_f32 v106, v106
    s_cmp_lg_u32 s4, 3
    s_cbranch_scc1 L_ni28
    s_nop 7
    v_mov_b32 v128, 0xff800000
    v_mov_b32 v129, 0xff800000
    v_mov_b32 v130, 0xff800000
    v_mov_b32 v131, 0xff800000
    v_mov_b32 v132, 0xff800000
    v_mov_b32 v133, 0xff800000
    v_mov_b32 v134, 0xff800000
    v_mov_b32 v135, 0xff800000
    v_mov_b32 v136, 0xff800000
    v_mov_b32 v137, 0xff800000
    v_mov_b32 v138, 0xff800000
    v_mov_b32 v139, 0xff800000
    v_mov_b32 v140, 0xff800000
    v_mov_b32 v141, 0xff800000
    v_mov_b32 v142, 0xff800000
    v_mov_b32 v143, 0xff800000
L_ni28:
    s_nop 1
    v_mfma_f32_32x32x16_bf16 v[80:95], v[160:163], v[28:31], v[128:143]
    v_exp_f32 v107, v107
    v_exp_f32 v108, v108
    v_exp_f32 v109, v109
    v_exp_f32 v110, v110
    v_exp_f32 v111, v111
    v_cvt_pk_bf16_f32 v96, v96, v97
    v_cvt_pk_bf16_f32 v97, v98, v99
    v_cvt_pk_bf16_f32 v98, v100, v101
    v_cvt_pk_bf16_f32 v99, v102, v103
    v_cvt_pk_bf16_f32 v100, v104, v105
    v_cvt_pk_bf16_f32 v101, v106, v107
    v_cvt_pk_bf16_f32 v102, v108, v109
    v_cvt_pk_bf16_f32 v103, v110, v111
    s_waitcnt lgkmcnt(0)
    s_mov_b64 exec, s[28:29]
    ds_read_b128 v[216:219], v246 offset:5120
    ds_read_b128 v[220:223], v246 offset:5632
    s_mov_b64 exec, -1
    v_exp_f32 v112, v112
    v_mfma_f32_32x32x16_bf16 v[200:215], v[224:227], v[96:99], v[200:215]
    v_exp_f32 v113, v113
    v_exp_f32 v114, v114
    v_exp_f32 v115, v115
    v_exp_f32 v116, v116
    v_exp_f32 v117, v117
    v_mfma_f32_32x32x16_bf16 v[200:215], v[228:231], v[100:103], v[200:215]
    v_exp_f32 v118, v118
    v_exp_f32 v119, v119
    v_exp_f32 v120, v120
    v_exp_f32 v121, v121
    v_exp_f32 v122, v122
    s_cmp_lg_u32 s4, 4
    s_cbranch_scc1 L_ni29
    s_nop 7
    v_mov_b32 v128, 0xff800000
    v_mov_b32 v129, 0xff800000
    v_mov_b32 v130, 0xff800000
    v_mov_b32 v131, 0xff800000
    v_mov_b32 v132, 0xff800000
    v_mov_b32 v133, 0xff800000
    v_mov_b32 v134, 0xff800000
    v_mov_b32 v135, 0xff800000
    v_mov_b32 v136, 0xff800000
    v_mov_b32 v137, 0xff800000
    v_mov_b32 v138, 0xff800000
    v_mov_b32 v139, 0xff800000
    v_mov_b32 v140, 0xff800000
    v_mov_b32 v141, 0xff800000
    v_mov_b32 v142, 0xff800000
    v_mov_b32 v143, 0xff800000
L_ni29:
    s_nop 1
    v_mfma_f32_32x32x16_bf16 v[96:111], v[156:159], v[28:31], v[128:143]
    v_exp_f32 v123, v123
    v_exp_f32 v124, v124
    v_exp_f32 v125, v125
    v_exp_f32 v126, v126
    v_exp_f32 v127, v127
    v_cvt_pk_bf16_f32 v112, v112, v113
    v_cvt_pk_bf16_f32 v113, v114, v115
    v_cvt_pk_bf16_f32 v114, v116, v117
    v_cvt_pk_bf16_f32 v115, v118, v119
    v_cvt_pk_bf16_f32 v116, v120, v121
    v_cvt_pk_bf16_f32 v117, v122, v123
    v_cvt_pk_bf16_f32 v118, v124, v125
    v_cvt_pk_bf16_f32 v119, v126, v127
    s_waitcnt lgkmcnt(0)
    s_mov_b64 exec, s[28:29]
    ds_read_b128 v[224:227], v246 offset:4096
    ds_read_b128 v[228:231], v246 offset:4608
    s_mov_b64 exec, -1
    v_exp_f32 v80, v80
    v_mfma_f32_32x32x16_bf16 v[200:215], v[216:219], v[112:115], v[200:215]
    v_exp_f32 v81, v81
    v_exp_f32 v82, v82
    v_exp_f32 v83, v83
    v_exp_f32 v84, v84
    v_exp_f32 v85, v85
    v_mfma_f32_32x32x16_bf16 v[200:215], v[220:223], v[116:119], v[200:215]
    v_exp_f32 v86, v86
    v_exp_f32 v87, v87
    v_exp_f32 v88, v88
    v_exp_f32 v89, v89
    v_exp_f32 v90, v90
    s_cmp_lg_u32 s4, 5
    s_cbranch_scc1 L_ni30
    s_nop 7
    v_mov_b32 v128, 0xff800000
    v_mov_b32 v129, 0xff800000
    v_mov_b32 v130, 0xff800000
    v_mov_b32 v131, 0xff800000
    v_mov_b32 v132, 0xff800000
    v_mov_b32 v133, 0xff800000
    v_mov_b32 v134, 0xff800000
    v_mov_b32 v135, 0xff800000
    v_mov_b32 v136, 0xff800000
    v_mov_b32 v137, 0xff800000
    v_mov_b32 v138, 0xff800000
    v_mov_b32 v139, 0xff800000
    v_mov_b32 v140, 0xff800000
    v_mov_b32 v141, 0xff800000
    v_mov_b32 v142, 0xff800000
    v_mov_b32 v143, 0xff800000
L_ni30:
    s_nop 1
    v_mfma_f32_32x32x16_bf16 v[112:127], v[152:155], v[28:31], v[128:143]
    v_exp_f32 v91, v91
    v_exp_f32 v92, v92
    v_exp_f32 v93, v93
    v_exp_f32 v94, v94
    v_exp_f32 v95, v95
    v_cvt_pk_bf16_f32 v80, v80, v81
    v_cvt_pk_bf16_f32 v81, v82, v83
    v_cvt_pk_bf16_f32 v82, v84, v85
    v_cvt_pk_bf16_f32 v83, v86, v87
    v_cvt_pk_bf16_f32 v84, v88, v89
    v_cvt_pk_bf16_f32 v85, v90, v91
    v_cvt_pk_bf16_f32 v86, v92, v93
    v_cvt_pk_bf16_f32 v87, v94, v95
    s_waitcnt lgkmcnt(0)
    s_mov_b64 exec, s[28:29]
    ds_read_b128 v[216:219], v246 offset:3072
    ds_read_b128 v[220:223], v246 offset:3584
    s_mov_b64 exec, -1
    v_exp_f32 v96, v96
    v_mfma_f32_32x32x16_bf16 v[200:215], v[224:227], v[80:83], v[200:215]
    v_exp_f32 v97, v97
    v_exp_f32 v98, v98
    v_exp_f32 v99, v99
    v_exp_f32 v100, v100
    v_exp_f32 v101, v101
    v_mfma_f32_32x32x16_bf16 v[200:215], v[228:231], v[84:87], v[200:215]
    v_exp_f32 v102, v102
    v_exp_f32 v103, v103
    v_exp_f32 v104, v104
    v_exp_f32 v105, v105
    v_exp_f32 v106, v106
    s_cmp_lg_u32 s4, 6
    s_cbranch_scc1 L_ni31
    s_nop 7
    v_mov_b32 v128, 0xff800000
    v_mov_b32 v129, 0xff800000
    v_mov_b32 v130, 0xff800000
    v_mov_b32 v131, 0xff800000
    v_mov_b32 v132, 0xff800000
    v_mov_b32 v133, 0xff800000
    v_mov_b32 v134, 0xff800000
    v_mov_b32 v135, 0xff800000
    v_mov_b32 v136, 0xff800000
    v_mov_b32 v137, 0xff800000
    v_mov_b32 v138, 0xff800000
    v_mov_b32 v139, 0xff800000
    v_mov_b32 v140, 0xff800000
    v_mov_b32 v141, 0xff800000
    v_mov_b32 v142, 0xff800000
    v_mov_b32 v143, 0xff800000
L_ni31:
    s_nop 1
    v_mfma_f32_32x32x16_bf16 v[80:95], v[148:151], v[28:31], v[128:143]
    v_exp_f32 v107, v107
    v_exp_f32 v108, v108
    v_exp_f32 v109, v109
    v_exp_f32 v110, v110
    v_exp_f32 v111, v111
    v_cvt_pk_bf16_f32 v96, v96, v97
    v_cvt_pk_bf16_f32 v97, v98, v99
    v_cvt_pk_bf16_f32 v98, v100, v101
    v_cvt_pk_bf16_f32 v99, v102, v103
    v_cvt_pk_bf16_f32 v100, v104, v105
    v_cvt_pk_bf16_f32 v101, v106, v107
    v_cvt_pk_bf16_f32 v102, v108, v109
    v_cvt_pk_bf16_f32 v103, v110, v111
    s_waitcnt lgkmcnt(0)
    s_mov_b64 exec, s[28:29]
    ds_read_b128 v[224:227], v246 offset:2048
    ds_read_b128 v[228:231], v246 offset:2560
    s_mov_b64 exec, -1
    v_exp_f32 v112, v112
    v_mfma_f32_32x32x16_bf16 v[200:215], v[216:219], v[96:99], v[200:215]
    v_exp_f32 v113, v113
    v_exp_f32 v114, v114
    v_exp_f32 v115, v115
    v_exp_f32 v116, v116
    v_exp_f32 v117, v117
    v_exp_f32 v118, v118
    v_exp_f32 v119, v119
    v_exp_f32 v120, v120
    v_mfma_f32_32x32x16_bf16 v[200:215], v[220:223], v[100:103], v[200:215]
    v_exp_f32 v121, v121
    v_exp_f32 v122, v122
    v_exp_f32 v123, v123
    v_exp_f32 v124, v124
    v_exp_f32 v125, v125
    v_exp_f32 v126, v126
    v_exp_f32 v127, v127
    v_cvt_pk_bf16_f32 v112, v112, v113
    v_cvt_pk_bf16_f32 v113, v114, v115
    v_cvt_pk_bf16_f32 v114, v116, v117
    v_cvt_pk_bf16_f32 v115, v118, v119
    v_cvt_pk_bf16_f32 v116, v120, v121
    v_cvt_pk_bf16_f32 v117, v122, v123
    v_cvt_pk_bf16_f32 v118, v124, v125
    v_cvt_pk_bf16_f32 v119, v126, v127
    s_waitcnt lgkmcnt(0)
    s_mov_b64 exec, s[28:29]
    ds_read_b128 v[216:219], v246 offset:1024
    ds_read_b128 v[220:223], v246 offset:1536
    s_mov_b64 exec, -1
    v_exp_f32 v80, v80
    v_mfma_f32_32x32x16_bf16 v[200:215], v[224:227], v[112:115], v[200:215]
    v_exp_f32 v81, v81
    v_exp_f32 v82, v82
    v_exp_f32 v83, v83
    v_exp_f32 v84, v84
    v_exp_f32 v85, v85
    v_exp_f32 v86, v86
    v_exp_f32 v87, v87
    v_exp_f32 v88, v88
    v_mfma_f32_32x32x16_bf16 v[200:215], v[228:231], v[116:119], v[200:215]
    v_exp_f32 v89, v89
    v_exp_f32 v90, v90
    v_exp_f32 v91, v91
    v_exp_f32 v92, v92
    v_exp_f32 v93, v93
    v_exp_f32 v94, v94
    v_exp_f32 v95, v95
    v_cvt_pk_bf16_f32 v80, v80, v81
    v_cvt_pk_bf16_f32 v81, v82, v83
    v_cvt_pk_bf16_f32 v82, v84, v85
    v_cvt_pk_bf16_f32 v83, v86, v87
    v_cvt_pk_bf16_f32 v84, v88, v89
    v_cvt_pk_bf16_f32 v85, v90, v91
    v_cvt_pk_bf16_f32 v86, v92, v93
    v_cvt_pk_bf16_f32 v87, v94, v95
    s_waitcnt lgkmcnt(1)
    v_mfma_f32_32x32x16_bf16 v[200:215], v[216:219], v[80:83], v[200:215]
    s_waitcnt lgkmcnt(0)
    v_mfma_f32_32x32x16_bf16 v[200:215], v[220:223], v[84:87], v[200:215]
    s_nop 11
    s_branch L_bdone2
L_kexa:
    s_nop 15
    v_mfma_f32_32x32x16_bf16 v[96:111], v[56:59], v[160:163], 0
    v_mfma_f32_32x32x16_bf16 v[96:111], v[60:63], v[164:167], v[96:111]
    v_mfma_f32_32x32x16_bf16 v[112:127], v[56:59], v[208:211], 0
    v_mfma_f32_32x32x16_bf16 v[112:127], v[60:63], v[212:215], v[112:127]
    s_nop 9
    v_max3_f32 v2, v96, v97, v98
    s_nop 0
    v_max3_f32 v4, v112, v113, v114
    v_max3_f32 v3, -v96, -v97, -v98
    v_max3_f32 v5, -v112, -v113, -v114
    v_max3_f32 v2, v2, v99, v100
    v_max3_f32 v4, v4, v115, v116
    v_max3_f32 v3, v3, -v99, -v100
    v_max3_f32 v5, v5, -v115, -v116
    v_max3_f32 v2, v2, v101, v102
    v_max3_f32 v4, v4, v117, v118
    v_max3_f32 v3, v3, -v101, -v102
    v_max3_f32 v5, v5, -v117, -v118
    v_max_f32_e64 v2, v2, v103
    v_max_f32_e64 v4, v4, v119
    v_max_f32_e64 v3, v3, -v103
    v_max_f32_e64 v5, v5, -v119
    s_nop 0
    v_permlane32_swap_b32 v2, v3
    v_permlane32_swap_b32 v4, v5
    v_max_f32 v2, v2, v3
    v_max_f32 v4, v4, v5
    v_mul_f32 v2, s62, v2
    v_mul_f32 v4, s62, v4
    v_mov_b32 v3, v2
    v_mov_b32 v5, v4
    s_nop 0
    v_permlane32_swap_b32 v2, v3
    v_permlane32_swap_b32 v4, v5
    v_fma_f32 v16, -v96, s62, -v3
    v_fma_f32 v24, -v112, s62, -v5
    v_fma_f32 v96, v96, s62, -v2
    v_fma_f32 v112, v112, s62, -v4
    v_fma_f32 v17, -v97, s62, -v3
    v_fma_f32 v25, -v113, s62, -v5
    v_fma_f32 v97, v97, s62, -v2
    v_fma_f32 v113, v113, s62, -v4
    v_fma_f32 v18, -v98, s62, -v3
    v_fma_f32 v26, -v114, s62, -v5
    v_fma_f32 v98, v98, s62, -v2
    v_fma_f32 v114, v114, s62, -v4
    v_fma_f32 v19, -v99, s62, -v3
    v_fma_f32 v27, -v115, s62, -v5
    v_fma_f32 v99, v99, s62, -v2
    v_fma_f32 v115, v115, s62, -v4
    v_fma_f32 v20, -v100, s62, -v3
    v_fma_f32 v28, -v116, s62, -v5
    v_fma_f32 v100, v100, s62, -v2
    v_fma_f32 v116, v116, s62, -v4
    v_fma_f32 v21, -v101, s62, -v3
    v_fma_f32 v29, -v117, s62, -v5
    v_fma_f32 v101, v101, s62, -v2
    v_fma_f32 v117, v117, s62, -v4
    v_fma_f32 v22, -v102, s62, -v3
    v_fma_f32 v30, -v118, s62, -v5
    v_fma_f32 v102, v102, s62, -v2
    v_fma_f32 v118, v118, s62, -v4
    v_fma_f32 v23, -v103, s62, -v3
    v_fma_f32 v31, -v119, s62, -v5
    v_fma_f32 v103, v103, s62, -v2
    v_fma_f32 v119, v119, s62, -v4
    v_exp_f32 v16, v16
    v_exp_f32 v24, v24
    v_exp_f32 v96, v96
    v_exp_f32 v112, v112
    v_exp_f32 v17, v17
    v_exp_f32 v25, v25
    v_exp_f32 v97, v97
    v_exp_f32 v113, v113
    v_exp_f32 v18, v18
    v_exp_f32 v26, v26
    v_exp_f32 v98, v98
    v_exp_f32 v114, v114
    v_exp_f32 v19, v19
    v_exp_f32 v27, v27
    v_exp_f32 v99, v99
    v_exp_f32 v115, v115
    v_exp_f32 v20, v20
    v_exp_f32 v28, v28
    v_exp_f32 v100, v100
    v_exp_f32 v116, v116
    v_exp_f32 v21, v21
    v_exp_f32 v29, v29
    v_exp_f32 v101, v101
    v_exp_f32 v117, v117
    v_exp_f32 v22, v22
    v_exp_f32 v30, v30
    v_exp_f32 v102, v102
    v_exp_f32 v118, v118
    v_exp_f32 v23, v23
    v_exp_f32 v31, v31
    v_exp_f32 v103, v103
    v_exp_f32 v119, v119
    v_add_f32 v2, v96, v97
    v_add_f32 v4, v112, v113
    v_add_f32 v3, v16, v17
    v_add_f32 v5, v24, v25
    v_add_f32 v2, v2, v98
    v_add_f32 v4, v4, v114
    v_add_f32 v3, v3, v18
    v_add_f32 v5, v5, v26
    v_add_f32 v2, v2, v99
    v_add_f32 v4, v4, v115
    v_add_f32 v3, v3, v19
    v_add_f32 v5, v5, v27
    v_add_f32 v2, v2, v100
    v_add_f32 v4, v4, v116
    v_add_f32 v3, v3, v20
    v_add_f32 v5, v5, v28
    v_add_f32 v2, v2, v101
    v_add_f32 v4, v4, v117
    v_add_f32 v3, v3, v21
    v_add_f32 v5, v5, v29
    v_add_f32 v2, v2, v102
    v_add_f32 v4, v4, v118
    v_add_f32 v3, v3, v22
    v_add_f32 v5, v5, v30
    v_add_f32 v2, v2, v103
    v_add_f32 v4, v4, v119
    v_add_f32 v3, v3, v23
    v_add_f32 v5, v5, v31
    s_nop 0
    v_permlane32_swap_b32 v2, v3
    v_permlane32_swap_b32 v4, v5
    v_add_f32 v2, v2, v3
    v_add_f32 v4, v4, v5
    v_rcp_f32 v2, v2
    v_rcp_f32 v4, v4
    v_mov_b32 v3, v2
    v_mov_b32 v5, v4
    s_nop 0
    v_permlane32_swap_b32 v2, v3
    v_permlane32_swap_b32 v4, v5
    v_mul_f32 v96, v96, v2
    v_mul_f32 v112, v112, v4
    v_mul_f32 v97, v97, v2
    v_mul_f32 v113, v113, v4
    v_mul_f32 v98, v98, v2
    v_mul_f32 v114, v114, v4
    v_mul_f32 v99, v99, v2
    v_mul_f32 v115, v115, v4
    v_mul_f32 v100, v100, v2
    v_mul_f32 v116, v116, v4
    v_mul_f32 v101, v101, v2
    v_mul_f32 v117, v117, v4
    v_mul_f32 v102, v102, v2
    v_mul_f32 v118, v118, v4
    v_mul_f32 v103, v103, v2
    v_mul_f32 v119, v119, v4
    v_cvt_pk_bf16_f32 v96, v96, v97
    v_cvt_pk_bf16_f32 v112, v112, v113
    v_cvt_pk_bf16_f32 v97, v98, v99
    v_cvt_pk_bf16_f32 v113, v114, v115
    v_cvt_pk_bf16_f32 v98, v100, v101
    v_cvt_pk_bf16_f32 v114, v116, v117
    v_cvt_pk_bf16_f32 v99, v102, v103
    v_cvt_pk_bf16_f32 v115, v118, v119
    v_mul_f32 v16, v16, v3
    v_mul_f32 v24, v24, v5
    v_mul_f32 v17, v17, v3
    v_mul_f32 v25, v25, v5
    v_mfma_f32_32x32x16_bf16 v[64:79], v[96:99], v[200:203], 0
    v_mfma_f32_32x32x16_bf16 v[80:95], v[112:115], v[200:203], 0
    v_mul_f32 v18, v18, v3
    v_mul_f32 v26, v26, v5
    v_mul_f32 v19, v19, v3
    v_mul_f32 v27, v27, v5
    v_mul_f32 v20, v20, v3
    v_mul_f32 v28, v28, v5
    v_mul_f32 v21, v21, v3
    v_mul_f32 v29, v29, v5
    v_mul_f32 v22, v22, v3
    v_mul_f32 v30, v30, v5
    v_mul_f32 v23, v23, v3
    v_mul_f32 v31, v31, v5
    v_cvt_pk_bf16_f32 v16, v16, v17
    v_cvt_pk_bf16_f32 v24, v24, v25
    v_cvt_pk_bf16_f32 v17, v18, v19
    v_cvt_pk_bf16_f32 v25, v26, v27
    v_cvt_pk_bf16_f32 v18, v20, v21
    v_cvt_pk_bf16_f32 v26, v28, v29
    v_cvt_pk_bf16_f32 v19, v22, v23
    v_cvt_pk_bf16_f32 v27, v30, v31
    s_nop 0
    v_mfma_f32_32x32x16_bf16 v[64:79], v[16:19], v[204:207], v[64:79]
    v_mfma_f32_32x32x16_bf16 v[80:95], v[24:27], v[204:207], v[80:95]
    s_nop 10
    v_cvt_pk_bf16_f32 v64, v64, v65
    v_cvt_pk_bf16_f32 v65, v66, v67
    v_cvt_pk_bf16_f32 v66, v68, v69
    v_cvt_pk_bf16_f32 v67, v70, v71
    v_cvt_pk_bf16_f32 v68, v72, v73
    v_cvt_pk_bf16_f32 v69, v74, v75
    v_cvt_pk_bf16_f32 v70, v76, v77
    v_cvt_pk_bf16_f32 v71, v78, v79
    v_cvt_pk_bf16_f32 v72, v80, v81
    v_cvt_pk_bf16_f32 v73, v82, v83
    v_cvt_pk_bf16_f32 v74, v84, v85
    v_cvt_pk_bf16_f32 v75, v86, v87
    v_cvt_pk_bf16_f32 v76, v88, v89
    v_cvt_pk_bf16_f32 v77, v90, v91
    v_cvt_pk_bf16_f32 v78, v92, v93
    v_cvt_pk_bf16_f32 v79, v94, v95
    v_mfma_f32_32x32x16_bf16 v[128:143], v[168:171], v[64:67], 0
    v_mfma_f32_32x32x16_bf16 v[128:143], v[172:175], v[68:71], v[128:143]
    v_mfma_f32_32x32x16_bf16 v[128:143], v[176:179], v[72:75], v[128:143]
    v_mfma_f32_32x32x16_bf16 v[128:143], v[180:183], v[76:79], v[128:143]
    s_nop 11
    ds_write_b128 v52, v[128:131]
    ds_write_b128 v52, v[132:135] offset:1024
    ds_write_b32 v52, v136 offset:2048
    ds_write_b32 v48, v243
    v_max3_f32 v12, v104, v105, v106
    v_max3_f32 v14, v120, v121, v122
    v_max3_f32 v13, -v104, -v105, -v106
    v_max3_f32 v15, -v120, -v121, -v122
    v_max3_f32 v12, v12, v107, v108
    v_max3_f32 v14, v14, v123, v124
    v_max3_f32 v13, v13, -v107, -v108
    v_max3_f32 v15, v15, -v123, -v124
    v_max3_f32 v12, v12, v109, v110
    v_max3_f32 v14, v14, v125, v126
    v_max3_f32 v13, v13, -v109, -v110
    v_max3_f32 v15, v15, -v125, -v126
    v_max_f32_e64 v12, v12, v111
    v_max_f32_e64 v14, v14, v127
    v_max_f32_e64 v13, v13, -v111
    v_max_f32_e64 v15, v15, -v127
    s_nop 0
    v_permlane32_swap_b32 v12, v13
    v_permlane32_swap_b32 v14, v15
    v_max_f32 v12, v12, v13
    v_max_f32 v14, v14, v15
    v_mul_f32 v12, s62, v12
    v_mul_f32 v14, s62, v14
    v_mov_b32 v13, v12
    v_mov_b32 v15, v14
    s_nop 0
    v_permlane32_swap_b32 v12, v13
    v_permlane32_swap_b32 v14, v15
    v_fma_f32 v32, -v104, s62, -v13
    v_fma_f32 v40, -v120, s62, -v15
    v_fma_f32 v104, v104, s62, -v12
    v_fma_f32 v120, v120, s62, -v14
    v_fma_f32 v33, -v105, s62, -v13
    v_fma_f32 v41, -v121, s62, -v15
    v_fma_f32 v105, v105, s62, -v12
    v_fma_f32 v121, v121, s62, -v14
    v_fma_f32 v34, -v106, s62, -v13
    v_fma_f32 v42, -v122, s62, -v15
    v_fma_f32 v106, v106, s62, -v12
    v_fma_f32 v122, v122, s62, -v14
    v_fma_f32 v35, -v107, s62, -v13
    v_fma_f32 v43, -v123, s62, -v15
    v_fma_f32 v107, v107, s62, -v12
    v_fma_f32 v123, v123, s62, -v14
    v_fma_f32 v36, -v108, s62, -v13
    v_fma_f32 v44, -v124, s62, -v15
    v_fma_f32 v108, v108, s62, -v12
    v_fma_f32 v124, v124, s62, -v14
    v_fma_f32 v37, -v109, s62, -v13
    v_fma_f32 v45, -v125, s62, -v15
    v_fma_f32 v109, v109, s62, -v12
    v_fma_f32 v125, v125, s62, -v14
    v_fma_f32 v38, -v110, s62, -v13
    v_fma_f32 v46, -v126, s62, -v15
    v_fma_f32 v110, v110, s62, -v12
    v_fma_f32 v126, v126, s62, -v14
    v_fma_f32 v39, -v111, s62, -v13
    v_fma_f32 v47, -v127, s62, -v15
    v_fma_f32 v111, v111, s62, -v12
    v_fma_f32 v127, v127, s62, -v14
    v_exp_f32 v32, v32
    v_exp_f32 v40, v40
    v_exp_f32 v104, v104
    v_exp_f32 v120, v120
    v_exp_f32 v33, v33
    v_exp_f32 v41, v41
    v_exp_f32 v105, v105
    v_exp_f32 v121, v121
    v_exp_f32 v34, v34
    v_exp_f32 v42, v42
    v_exp_f32 v106, v106
    v_exp_f32 v122, v122
    v_exp_f32 v35, v35
    v_exp_f32 v43, v43
    v_exp_f32 v107, v107
    v_exp_f32 v123, v123
    v_exp_f32 v36, v36
    v_exp_f32 v44, v44
    v_exp_f32 v108, v108
    v_exp_f32 v124, v124
    v_exp_f32 v37, v37
    v_exp_f32 v45, v45
    v_exp_f32 v109, v109
    v_exp_f32 v125, v125
    v_exp_f32 v38, v38
    v_exp_f32 v46, v46
    v_exp_f32 v110, v110
    v_exp_f32 v126, v126
    v_exp_f32 v39, v39
    v_exp_f32 v47, v47
    v_exp_f32 v111, v111
    v_exp_f32 v127, v127
    v_add_f32 v12, v104, v105
    v_add_f32 v14, v120, v121
    v_add_f32 v13, v32, v33
    v_add_f32 v15, v40, v41
    v_add_f32 v12, v12, v106
    v_add_f32 v14, v14, v122
    v_add_f32 v13, v13, v34
    v_add_f32 v15, v15, v42
    v_add_f32 v12, v12, v107
    v_add_f32 v14, v14, v123
    v_add_f32 v13, v13, v35
    v_add_f32 v15, v15, v43
    v_add_f32 v12, v12, v108
    v_add_f32 v14, v14, v124
    v_add_f32 v13, v13, v36
    v_add_f32 v15, v15, v44
    v_add_f32 v12, v12, v109
    v_add_f32 v14, v14, v125
    v_add_f32 v13, v13, v37
    v_add_f32 v15, v15, v45
    v_add_f32 v12, v12, v110
    v_add_f32 v14, v14, v126
    v_add_f32 v13, v13, v38
    v_add_f32 v15, v15, v46
    v_add_f32 v12, v12, v111
    v_add_f32 v14, v14, v127
    v_add_f32 v13, v13, v39
    v_add_f32 v15, v15, v47
    s_nop 0
    v_permlane32_swap_b32 v12, v13
    v_permlane32_swap_b32 v14, v15
    v_add_f32 v12, v12, v13
    v_add_f32 v14, v14, v15
    v_rcp_f32 v12, v12
    v_rcp_f32 v14, v14
    v_mov_b32 v13, v12
    v_mov_b32 v15, v14
    s_nop 0
    v_permlane32_swap_b32 v12, v13
    v_permlane32_swap_b32 v14, v15
    v_mul_f32 v104, v104, v12
    v_mul_f32 v120, v120, v14
    v_mul_f32 v105, v105, v12
    v_mul_f32 v121, v121, v14
    v_mul_f32 v106, v106, v12
    v_mul_f32 v122, v122, v14
    v_mul_f32 v107, v107, v12
    v_mul_f32 v123, v123, v14
    v_mul_f32 v108, v108, v12
    v_mul_f32 v124, v124, v14
    v_mul_f32 v109, v109, v12
    v_mul_f32 v125, v125, v14
    v_mul_f32 v110, v110, v12
    v_mul_f32 v126, v126, v14
    v_mul_f32 v111, v111, v12
    v_mul_f32 v127, v127, v14
    v_cvt_pk_bf16_f32 v104, v104, v105
    v_cvt_pk_bf16_f32 v120, v120, v121
    v_cvt_pk_bf16_f32 v105, v106, v107
    v_cvt_pk_bf16_f32 v121, v122, v123
    v_cvt_pk_bf16_f32 v106, v108, v109
    v_cvt_pk_bf16_f32 v122, v124, v125
    v_cvt_pk_bf16_f32 v107, v110, v111
    v_cvt_pk_bf16_f32 v123, v126, v127
    v_mul_f32 v32, v32, v13
    v_mul_f32 v40, v40, v15
    v_mul_f32 v33, v33, v13
    v_mul_f32 v41, v41, v15
    v_mfma_f32_32x32x16_bf16 v[80:95], v[104:107], v[200:203], 0
    v_mfma_f32_32x32x16_bf16 v[16:31], v[120:123], v[200:203], 0
    v_mul_f32 v34, v34, v13
    v_mul_f32 v42, v42, v15
    v_mul_f32 v35, v35, v13
    v_mul_f32 v43, v43, v15
    v_mul_f32 v36, v36, v13
    v_mul_f32 v44, v44, v15
    v_mul_f32 v37, v37, v13
    v_mul_f32 v45, v45, v15
    v_mul_f32 v38, v38, v13
    v_mul_f32 v46, v46, v15
    v_mul_f32 v39, v39, v13
    v_mul_f32 v47, v47, v15
    v_cvt_pk_bf16_f32 v32, v32, v33
    v_cvt_pk_bf16_f32 v40, v40, v41
    v_cvt_pk_bf16_f32 v33, v34, v35
    v_cvt_pk_bf16_f32 v41, v42, v43
    v_cvt_pk_bf16_f32 v34, v36, v37
    v_cvt_pk_bf16_f32 v42, v44, v45
    v_cvt_pk_bf16_f32 v35, v38, v39
    v_cvt_pk_bf16_f32 v43, v46, v47
    s_nop 0
    v_mfma_f32_32x32x16_bf16 v[80:95], v[32:35], v[204:207], v[80:95]
    v_mfma_f32_32x32x16_bf16 v[16:31], v[40:43], v[204:207], v[16:31]
    s_nop 1
    s_branch L_kdone
L_wrong:
    s_mov_b32 s99, s24
    s_or_b32 s2, s2, 256
    s_setprio 0
    s_waitcnt vmcnt(0) lgkmcnt(0)
    s_barrier
    s_nop 15
    s_load_dwordx16 s[4:19], s[0:1], 0
    s_load_dwordx4 s[20:23], s[0:1], 64
    s_branch L_restart
L_code_end:
.p2align 8
.fill 64, 4, 0xbf800000
.section .rodata,"a"
.p2align 6
.amdhsa_kernel concat_heads__linear_kernel_hedgehog__sliding_block__prompt_kernel
  .amdhsa_next_free_vgpr 256
  .amdhsa_next_free_sgpr 100
  .amdhsa_accum_offset 256
  .amdhsa_group_segment_fixed_size 0
  .amdhsa_kernarg_size 80
  .amdhsa_user_sgpr_count 2
  .amdhsa_user_sgpr_kernarg_segment_ptr 1
  .amdhsa_system_sgpr_workgroup_id_x 1
  .amdhsa_float_denorm_mode_32 3
  .amdhsa_float_denorm_mode_16_64 3
.end_amdhsa_kernel
```
